```python
import torch

def _softmax(x, axis=-1):
    return torch.softmax(x, dim=axis)
def _gelu(x):
    return torch.nn.functional.gelu(x, approximate="tanh")
def _silu(x):
    return torch.nn.functional.silu(x)
def _sigmoid(x):
    return torch.sigmoid(x)
def _layernorm(x, axis=-1, eps=1e-5):
    m = x.mean(dim=axis, keepdim=True)
    v = x.var(dim=axis, keepdim=True, unbiased=False)
    return (x - m) / torch.sqrt(v + eps)
def _scatter_add(tgt, idx, src, axis=0):
    return tgt.clone().index_add_(axis, idx, src)
def _segment_sum(src, seg, n):
    out = torch.zeros((n,) + src.shape[1:], dtype=src.dtype)
    return out.index_add_(0, seg, src)
def _pad(x, pw):
    flat = tuple(v for pair in reversed(pw) for v in pair)
    return torch.nn.functional.pad(x, flat)

kernel_name = 'sequential_preLN__ssm_conv_s4d__moe_arch_mod__prompt'

def setup_inputs():

    _w = (lambda a: (lambda t: t.to(torch.bfloat16) if t.is_floating_point() else t)(torch.as_tensor(a)))
    def _A_setup():
        Bsz, L, D, N = 1, 2048, 512, 128
        return {
            "u": _w((lambda *s: torch.randn(*s, dtype=torch.bfloat16) * 0.1)(Bsz, L, D)),
            "log_A_real": _w((lambda *s: torch.randn(*s, dtype=torch.bfloat16) * 6.4)(D, N) * 0.5),
            "A_imag": _w((lambda *s: torch.randn(*s, dtype=torch.bfloat16) * 0.1)(D, N) * 3.14),
            "C_real": _w((lambda *s: torch.randn(*s, dtype=torch.bfloat16) * 0.1)(D, N) / N ** 0.5),
            "C_imag": _w((lambda *s: torch.randn(*s, dtype=torch.bfloat16) * 0.1)(D, N) / N ** 0.5),
            "log_dt": _w((lambda *s: torch.randn(*s, dtype=torch.bfloat16) * 0.1)(D) * 0.5 - 4.0),
            "D_skip": _w((lambda *s: torch.randn(*s, dtype=torch.bfloat16) * 0.1)(D)),
        }
    _A_in = _A_setup()

    def _B_setup():
        B, S, D, F, C = 1, 2048, 512, 1792, 8
        return {
            "x": _w((lambda *s: torch.randn(*s, dtype=torch.bfloat16) * 0.1)(B, S, D)),
            "w_r": _w((lambda *s: torch.randn(*s, dtype=torch.bfloat16) * 0.1)(D)),
            "w_gate": _w((lambda *s: torch.randn(*s, dtype=torch.bfloat16) * 0.1)(D, F)),
            "w_up": _w((lambda *s: torch.randn(*s, dtype=torch.bfloat16) * 0.1)(D, F)),
            "w_down": _w((lambda *s: torch.randn(*s, dtype=torch.bfloat16) * 0.1)(F, D)),
        }
    _B_in = _B_setup()

    return {
        "A_u": _A_in["u"],
        "A_log_A_real": _A_in["log_A_real"],
        "A_A_imag": _A_in["A_imag"],
        "A_C_real": _A_in["C_real"],
        "A_C_imag": _A_in["C_imag"],
        "A_log_dt": _A_in["log_dt"],
        "A_D_skip": _A_in["D_skip"],
        "B_x": _B_in["x"],
        "B_w_r": _B_in["w_r"],
        "B_w_gate": _B_in["w_gate"],
        "B_w_up": _B_in["w_up"],
        "B_w_down": _B_in["w_down"],
    }

def reference(A_u, A_log_A_real, A_A_imag, A_C_real, A_C_imag, A_log_dt, A_D_skip, B_x, B_w_r, B_w_gate, B_w_up, B_w_down):
    def _A_ref(u, log_A_real, A_imag, C_real, C_imag, log_dt, D_skip):
        L = u.shape[1]
        dt = torch.exp(log_dt)
        A = -torch.exp(log_A_real) + 1j * A_imag
        C = (C_real + 1j * C_imag) * dt[:, None]
        pos = (lambda x, dt: x.to(dt))(torch.arange(L), log_dt.dtype)
        P = torch.exp((A * dt[:, None])[:, :, None] * pos[None, None, :])
        K = 2.0 * torch.einsum("dn,dnl->dl", C, P).real
        L2 = 2 * L
        u_t = (lambda x, *d: x.permute(*d))(u, 0, 2, 1)
        Kf = (lambda x, *a, **k: torch.fft.rfft(x.float(), *a, **k))(K, L2)
        Uf = (lambda x, *a, **k: torch.fft.rfft(x.float(), *a, **k))(u_t, L2)
        y = (lambda x, *a, **k: torch.fft.irfft(x, *a, **k).to(torch.bfloat16))(Uf * Kf[None, :, :], L2)[:, :, :L]
        y = (lambda x, *d: x.permute(*d))(y, 0, 2, 1)
        return y + u * D_skip[None, None, :]

    def _B_ref(x, w_r, w_gate, w_up, w_down):
        B, S, D = x.shape
        C = 8
        r = x @ w_r
        idx = torch.argsort(-r, axis=-1)[:, :C]
        idx_e = (lambda x, n, axis: torch.repeat_interleave(x, n, dim=axis))(idx.reshape(B, C, 1), D, axis=2)
        x_sel = (lambda x, i, axis: torch.take_along_dim(x, i, dim=axis))(x, idx_e, axis=1)
        g = _silu(x_sel @ w_gate)
        u = x_sel @ w_up
        y = (g * u) @ w_down
        r_sel = _sigmoid((lambda x, i, axis: torch.take_along_dim(x, i, dim=axis))(r, idx, axis=1))
        y = y * r_sel.reshape(B, C, 1)
        b_off = (torch.arange(B) * S).reshape(B, 1)
        flat_idx = (idx + b_off).reshape(B * C)
        zero = (x * 0.0).reshape(B * S, D)
        upd = _scatter_add(zero, flat_idx, y.reshape(B * C, D), axis=0)
        return x + upd.reshape(B, S, D)

    x = A_u
    h = x + _A_ref(_layernorm(x, axis=-1), A_log_A_real, A_A_imag, A_C_real, A_C_imag, A_log_dt, A_D_skip)
    h2 = h + _B_ref(_layernorm(h, axis=-1), B_w_r, B_w_gate, B_w_up, B_w_down)
    return h2
```

```asm
; @launch grid=(256,1,1) block=(512,1,1) lds=154112
.amdgcn_target "amdgcn-amd-amdhsa--gfx950"
.text
.globl sequential_preLN__ssm_conv_s4d__moe_arch_mod__prompt_kernel
.p2align 8
.type sequential_preLN__ssm_conv_s4d__moe_arch_mod__prompt_kernel,@function
sequential_preLN__ssm_conv_s4d__moe_arch_mod__prompt_kernel:
    s_cmp_ge_u32 s2, 256
    s_cbranch_scc1 L_end
    s_load_dwordx16 s[8:23], s[0:1], 0
    s_load_dwordx8 s[24:31], s[0:1], 64
    s_load_dwordx4 s[32:35], s[0:1], 96
    s_load_dwordx2 s[36:37], s[0:1], 112
    v_lshrrev_b32 v2, 6, v0
    v_and_b32 v1, 63, v0
    s_and_b32 s6, s2, 7
    s_lshl_b32 s6, s6, 5
    s_lshr_b32 s7, s2, 3
    s_add_u32 s3, s6, s7
    v_readfirstlane_b32 s4, v2
    s_and_b32 s6, s2, 7
    s_mul_i32 s7, s6, 7
    s_lshr_b32 s61, s2, 3
    s_add_u32 s7, s7, s61
    s_lshl_b32 s6, s6, 2
    s_add_u32 s6, s6, s61
    s_sub_u32 s6, s6, 8
    s_cmp_lt_u32 s2, 56
    s_cselect_b32 s61, s7, s6
    v_and_b32 v8, 7, v1
    v_lshrrev_b32 v9, 3, v1
    s_lshl_b32 s6, s4, 7
    v_lshl_add_u32 v10, v9, 4, s6
    s_lshl_b32 s7, s3, 13
    v_lshl_add_u32 v11, v8, 10, s7
    v_add_u32 v12, v11, v10
    v_lshl_add_u32 v13, v0, 4, s7
    s_lshl_b32 s6, s3, 9
    v_and_b32 v14, 255, v0
    v_lshl_add_u32 v14, v14, 1, s6
    v_xor_b32 v15, 128, v14
    s_lshl_b32 s6, s3, 2
    v_bfe_u32 v16, v0, 7, 1
    v_lshl_add_u32 v16, v16, 1, s6
    v_lshlrev_b32 v2, 4, v1
    s_waitcnt lgkmcnt(0)
    global_load_dwordx4 v[18:21], v12, s[8:9]
    s_load_dword s5, s[36:37], 0
    s_cmp_eq_u32 s4, 6
    s_cbranch_scc0 L_s0_n6
    global_load_dwordx4 v[22:25], v2, s[20:21]
L_s0_n6:
    s_cmp_eq_u32 s4, 7
    s_cbranch_scc0 L_s0_n7
    global_load_dwordx4 v[22:25], v2, s[24:25]
L_s0_n7:
    s_barrier
    v_mov_b32 v32, -1
    v_mov_b32 v33, -1
    v_mov_b32 v34, -1
    v_mov_b32 v35, -1
    s_mul_i32 s6, s2, 768
    s_mul_i32 s7, s4, 96
    s_add_u32 s6, s6, s7
    s_add_u32 s6, s6, 65536
    v_lshl_add_u32 v3, v1, 4, s6
    v_add_u32 v4, 1048576, v13
    v_add_u32 v5, 3145728, v13
    global_store_dwordx4 v4, v[32:35], s[36:37] sc1
    s_mov_b64 exec, 0x3f
    global_store_dwordx4 v3, v[32:35], s[36:37] sc1
    s_mov_b64 exec, -1
    s_cmp_ge_u32 s4, 4
    s_cbranch_scc1 L_s0_nopar
    global_load_ushort v17, v14, s[10:11]
    global_load_ushort v26, v14, s[12:13]
    global_load_ushort v27, v14, s[14:15]
    global_load_ushort v28, v14, s[16:17]
    global_load_ushort v29, v15, s[14:15]
    global_load_ushort v30, v15, s[16:17]
    global_load_ushort v31, v16, s[18:19]
    s_branch L_s0_par
L_s0_nopar:
    s_cmp_ge_u32 s4, 6
    s_cbranch_scc1 L_s0_parB
    s_getpc_b64 s[38:39]
L_pc_here:
    s_sub_u32 s6, s4, 4
    s_lshl_b32 s6, s6, 13
    v_lshl_add_u32 v7, v1, 7, s6
    v_min_u32 v7, L_end-L_pc_here, v7
    global_load_dword v6, v7, s[38:39]
    v_add_u32 v7, 16384, v7
    v_min_u32 v7, L_end-L_pc_here, v7
    global_load_dword v6, v7, s[38:39]
L_s0_parB:
    global_load_ushort v17, v14, s[10:11]
    global_load_ushort v26, v14, s[12:13]
    global_load_ushort v31, v16, s[18:19]
L_s0_par:
    s_mov_b32 s62, 0x3fb8aa3b
    s_mov_b32 s63, 0x32a57060
    s_mov_b32 s64, 0x3e22f983
    s_mov_b32 s65, 0x31dc9c88
    s_mov_b32 s66, 0x3727c5ac
    s_mov_b32 s67, 0xffff0000
    s_mov_b32 s68, 0x3f803f80
    v_mov_b32 v36, 0
    v_mov_b32 v37, 0
    v_mov_b32 v38, 0
    v_mov_b32 v39, 0
    s_cmp_eq_u32 s4, 4
    s_cbranch_scc0 L_s0_z1
    v_lshlrev_b32 v2, 4, v1
    v_add_u32 v3, 4096, v2
    v_cmp_gt_u32 vcc, 32, v1
    s_nop 1
    v_cndmask_b32 v2, v3, v2, vcc
    ds_write_b128 v2, v[36:39] offset:16640
L_s0_z1:
    s_cmp_eq_u32 s4, 5
    s_cbranch_scc0 L_s0_z2
    v_lshrrev_b32 v2, 1, v1
    v_mul_u32_u24 v2, 4160, v2
    v_and_b32 v3, 1, v1
    v_lshl_add_u32 v2, v3, 4, v2
    s_mov_b64 exec, 0xff
    ds_write_b128 v2, v[36:39] offset:4096
    s_mov_b64 exec, -1
L_s0_z2:
    v_and_b32 v2, 15, v1
    v_lshrrev_b32 v3, 4, v1
    s_cmp_ge_u32 s4, 4
    s_cbranch_scc1 L_s0_t2
    s_bitcmp1_b32 s4, 0
    s_cbranch_scc1 L_s0_t1
    v_lshrrev_b32 v4, 3, v2
    v_lshlrev_b32 v4, 7, v4
    v_and_b32 v5, 7, v2
    v_add_u32 v14, v4, v5
    v_mov_b32 v15, 8
    s_branch L_s0_td
L_s0_t1:
    v_lshrrev_b32 v4, 2, v2
    v_lshlrev_b32 v4, 6, v4
    v_and_b32 v5, 3, v2
    v_add_u32 v4, v4, v5
    v_add_u32 v14, 256, v4
    v_lshrrev_b32 v4, 1, v2
    v_lshlrev_b32 v4, 5, v4
    v_and_b32 v5, 1, v2
    v_add_u32 v4, v4, v5
    v_add_u32 v4, 256, v4
    v_cmp_gt_u32 vcc, 8, v2
    s_nop 1
    v_cndmask_b32 v14, v4, v14, vcc
    v_mov_b32 v4, 2
    v_mov_b32 v5, 4
    v_cndmask_b32 v15, v4, v5, vcc
    s_branch L_s0_td
L_s0_t2:
    v_lshlrev_b32 v14, 4, v2
    v_add_u32 v14, 512, v14
    v_mov_b32 v15, 1
L_s0_td:
    v_lshlrev_b32 v3, 2, v3
    v_mul_u32_u24 v3, v3, v15
    v_add_u32 v14, v14, v3
    v_lshlrev_b32 v14, 1, v14
    v_lshlrev_b32 v15, 1, v15
    s_lshr_b32 s40, s4, 1
    s_and_b32 s41, s4, 1
    s_sub_u32 s6, s4, 4
    s_cmp_ge_u32 s4, 4
    s_cselect_b32 s40, s6, s40
    s_cselect_b32 s41, 2, s41
    s_mul_i32 s6, s40, 1536
    s_add_u32 s6, s6, 25856
    v_add_u32 v14, s6, v14
    s_mul_i32 s6, s40, 34816
    s_add_u32 s6, s6, 47360
    v_and_b32 v2, 15, v1
    v_mul_u32_u24 v2, 544, v2
    v_lshrrev_b32 v3, 4, v1
    v_lshl_add_u32 v2, v3, 4, v2
    v_add_u32 v16, s6, v2
    s_mul_i32 s7, s41, 8704
    s_add_u32 s6, s6, s7
    s_add_u32 s6, s6, 8704
    v_add_u32 v36, s6, v2
    v_and_b32 v48, 255, v0
    v_lshlrev_b32 v62, 13, v48
    s_lshl_b32 s6, s3, 5
    s_add_u32 s6, s6, 1048576
    v_add_u32 v62, s6, v62
    s_and_b32 s6, s2, 7
    s_lshl_b32 s6, s6, 12
    s_add_u32 s6, s6, 327680
    v_lshl_add_u32 v49, v1, 4, s6
    v_lshlrev_b32 v63, 4, v48
    s_cmp_ge_u32 s4, 4
    s_cbranch_scc1 L_s0_noexp
    v_sub_u32 v37, 255, v48
    v_lshlrev_b32 v37, 4, v37
    v_lshlrev_b32 v48, 3, v48
    v_add_u32 v48, 9, v48
    v_subrev_u32 v38, 0, v48
    v_cvt_f32_u32 v2, v38
    v_cvt_pk_bf16_f32 v2, v2, v2
    v_and_b32 v2, 0xffff, v2
    v_subrev_u32 v2, 17024, v2
    v_min_u32 v38, 128, v38
    v_max_i32 v38, v2, v38
    v_lshlrev_b32 v38, 1, v38
    v_subrev_u32 v39, 1, v48
    v_cvt_f32_u32 v2, v39
    v_cvt_pk_bf16_f32 v2, v2, v2
    v_and_b32 v2, 0xffff, v2
    v_subrev_u32 v2, 17024, v2
    v_min_u32 v39, 128, v39
    v_max_i32 v39, v2, v39
    v_lshlrev_b32 v39, 1, v39
    v_subrev_u32 v40, 2, v48
    v_cvt_f32_u32 v2, v40
    v_cvt_pk_bf16_f32 v2, v2, v2
    v_and_b32 v2, 0xffff, v2
    v_subrev_u32 v2, 17024, v2
    v_min_u32 v40, 128, v40
    v_max_i32 v40, v2, v40
    v_lshlrev_b32 v40, 1, v40
    v_subrev_u32 v41, 3, v48
    v_cvt_f32_u32 v2, v41
    v_cvt_pk_bf16_f32 v2, v2, v2
    v_and_b32 v2, 0xffff, v2
    v_subrev_u32 v2, 17024, v2
    v_min_u32 v41, 128, v41
    v_max_i32 v41, v2, v41
    v_lshlrev_b32 v41, 1, v41
    v_subrev_u32 v42, 4, v48
    v_cvt_f32_u32 v2, v42
    v_cvt_pk_bf16_f32 v2, v2, v2
    v_and_b32 v2, 0xffff, v2
    v_subrev_u32 v2, 17024, v2
    v_min_u32 v42, 128, v42
    v_max_i32 v42, v2, v42
    v_lshlrev_b32 v42, 1, v42
    v_subrev_u32 v43, 5, v48
    v_cvt_f32_u32 v2, v43
    v_cvt_pk_bf16_f32 v2, v2, v2
    v_and_b32 v2, 0xffff, v2
    v_subrev_u32 v2, 17024, v2
    v_min_u32 v43, 128, v43
    v_max_i32 v43, v2, v43
    v_lshlrev_b32 v43, 1, v43
    v_subrev_u32 v44, 6, v48
    v_cvt_f32_u32 v2, v44
    v_cvt_pk_bf16_f32 v2, v2, v2
    v_and_b32 v2, 0xffff, v2
    v_subrev_u32 v2, 17024, v2
    v_min_u32 v44, 128, v44
    v_max_i32 v44, v2, v44
    v_lshlrev_b32 v44, 1, v44
    v_subrev_u32 v45, 7, v48
    v_cvt_f32_u32 v2, v45
    v_cvt_pk_bf16_f32 v2, v2, v2
    v_and_b32 v2, 0xffff, v2
    v_subrev_u32 v2, 17024, v2
    v_min_u32 v45, 128, v45
    v_max_i32 v45, v2, v45
    v_lshlrev_b32 v45, 1, v45
    v_subrev_u32 v46, 8, v48
    v_cvt_f32_u32 v2, v46
    v_cvt_pk_bf16_f32 v2, v2, v2
    v_and_b32 v2, 0xffff, v2
    v_subrev_u32 v2, 17024, v2
    v_min_u32 v46, 128, v46
    v_max_i32 v46, v2, v46
    v_lshlrev_b32 v46, 1, v46
    v_subrev_u32 v47, 9, v48
    v_cvt_f32_u32 v2, v47
    v_cvt_pk_bf16_f32 v2, v2, v2
    v_and_b32 v2, 0xffff, v2
    v_subrev_u32 v2, 17024, v2
    v_min_u32 v47, 128, v47
    v_max_i32 v47, v2, v47
    v_lshlrev_b32 v47, 1, v47
L_s0_noexp:
    v_lshrrev_b32 v2, 1, v0
    v_and_b32 v3, 1, v0
    v_mul_u32_u24 v48, 9280, v3
    v_lshrrev_b32 v5, 5, v2
    v_mul_u32_u24 v5, 1152, v5
    v_add_u32 v48, v48, v5
    v_bfe_u32 v5, v2, 1, 4
    v_lshl_add_u32 v48, v5, 4, v48
    v_and_b32 v5, 1, v2
    v_mul_u32_u24 v5, 640, v5
    v_add_u32 v48, v48, v5
    v_add_u32 v48, 116992, v48
    v_lshlrev_b32 v64, 2, v3
    v_add_u32 v65, 3145728, v13
    s_cmp_ge_u32 s4, 4
    s_cbranch_scc1 L_s0_nocv
    s_lshr_b32 s6, s4, 1
    s_and_b32 s7, s4, 1
    v_and_b32 v2, 15, v1
    v_lshrrev_b32 v3, 4, v1
    v_and_b32 v4, 1, v2
    v_mul_u32_u24 v5, 4162, v4
    v_lshl_add_u32 v5, v3, 4, v5
    v_lshlrev_b32 v4, 1, v2
    v_sub_u32 v5, v5, v4
    s_mul_i32 s38, s6, 8320
    s_lshl_b32 s39, s7, 8
    s_sub_u32 s38, s38, s39
    s_add_u32 s38, s38, 3104
    v_add_u32 v66, s38, v5
    v_subrev_u32 v67, 1024, v66
    v_subrev_u32 v68, 2048, v66
    v_subrev_u32 v69, 3072, v66
    v_lshl_add_u32 v4, v2, 1, v3
    s_mul_i32 s38, s6, 4608
    s_sub_u32 s38, s38, s39
    s_add_u32 s38, s38, 16928
    v_lshl_add_u32 v70, v4, 4, s38
    s_mul_i32 s38, s6, 9280
    s_mul_i32 s39, s7, 18560
    s_add_u32 s38, s38, s39
    s_add_u32 s38, s38, 116992
    v_lshrrev_b32 v2, 5, v1
    v_lshlrev_b32 v2, 7, v2
    v_lshl_add_u32 v2, v1, 4, v2
    v_add_u32 v71, s38, v2
L_s0_nocv:
    s_and_b32 s6, s2, 7
    s_lshr_b32 s7, s2, 3
    s_mul_i32 s38, s6, 448
    s_and_b32 s38, s38, 0xffffff80
    s_mul_i32 s39, s7, 57344
    s_add_u32 s38, s38, s39
    v_lshrrev_b32 v114, 2, v1
    v_mul_u32_u24 v114, 3584, v114
    v_and_b32 v2, 3, v1
    v_lshl_add_u32 v114, v2, 7, v114
    v_add_u32 v114, s38, v114
    v_min_u32 v114, 1835004, v114
    s_lshl_b32 s38, s6, 7
    s_mul_i32 s39, s7, 57344
    s_add_u32 s38, s38, s39
    s_and_b32 s39, s4, 1
    s_mul_i32 s39, s39, 28672
    s_add_u32 s38, s38, s39
    v_min_u32 v2, 27, v1
    v_lshl_add_u32 v2, v2, 10, s38
    s_cmp_ge_u32 s4, 2
    s_cselect_b64 vcc, -1, 0
    v_cndmask_b32 v114, v114, v2, vcc
    s_cmp_eq_u32 s4, 1
    s_cselect_b32 s44, s28, s26
    s_cselect_b32 s45, s29, s27
    s_cmp_ge_u32 s4, 2
    s_cselect_b32 s44, s30, s44
    s_cselect_b32 s45, s31, s45
    s_cmp_lt_u32 s4, 4
    s_cbranch_scc1 L_s1_wa
    s_cmp_lt_u32 s4, 6
    s_cbranch_scc1 L_s1_wb
    s_waitcnt vmcnt(5)
    s_branch L_s1_wd
L_s1_wb:
    s_waitcnt vmcnt(7)
    s_branch L_s1_wd
L_s1_wa:
    s_waitcnt vmcnt(9)
L_s1_wd:
    global_store_dwordx4 v65, v[32:35], s[36:37] sc1
    v_dot2_f32_bf16 v90, v18, s68, 0
    v_dot2_f32_bf16 v91, v18, v18, 0
    v_dot2_f32_bf16 v90, v19, s68, v90
    v_dot2_f32_bf16 v91, v19, v19, v91
    v_dot2_f32_bf16 v90, v20, s68, v90
    v_dot2_f32_bf16 v91, v20, v20, v91
    v_dot2_f32_bf16 v90, v21, s68, v90
    v_dot2_f32_bf16 v91, v21, v21, v91
    s_lshl_b32 s6, s4, 3
    s_nop 0
    v_add_f32_dpp v90, v90, v90 row_ror:8 row_mask:0xf bank_mask:0xf
    v_add_f32_dpp v91, v91, v91 row_ror:8 row_mask:0xf bank_mask:0xf
    v_mov_b32 v108, v90
    v_mov_b32 v109, v91
    s_nop 0
    v_permlane16_swap_b32 v108, v90
    v_permlane16_swap_b32 v109, v91
    v_pk_add_f32 v[90:91], v[90:91], v[108:109]
    v_mov_b32 v108, v90
    v_mov_b32 v109, v91
    s_nop 0
    v_permlane32_swap_b32 v108, v90
    v_permlane32_swap_b32 v109, v91
    v_pk_add_f32 v[90:91], v[90:91], v[108:109]
    v_lshl_add_u32 v108, v8, 6, s6
    s_mov_b64 exec, 0xff
    ds_write_b64 v108, v[90:91] offset:28928
    s_mov_b64 exec, -1
    v_lshlrev_b32 v72, 16, v18
    v_and_b32 v73, s67, v18
    v_lshlrev_b32 v74, 16, v19
    v_and_b32 v75, s67, v19
    v_lshlrev_b32 v76, 16, v20
    v_and_b32 v77, s67, v20
    v_lshlrev_b32 v78, 16, v21
    v_and_b32 v79, s67, v21
    s_cmp_lt_u32 s4, 6
    s_cbranch_scc1 L_s1_nodw
    s_sub_u32 s6, s4, 6
    s_lshl_b32 s6, s6, 10
    s_add_u32 s6, s6, 33024
    v_lshl_add_u32 v2, v1, 4, s6
    ds_write_b128 v2, v[22:25]
L_s1_nodw:
    s_cmp_lt_u32 s4, 4
    s_cbranch_scc1 L_s1_ca
    s_cmp_lt_u32 s4, 6
    s_cbranch_scc1 L_s1_cb
    s_waitcnt vmcnt(4) lgkmcnt(0)
    s_branch L_s1_cd
L_s1_cb:
    s_waitcnt vmcnt(6) lgkmcnt(0)
    s_branch L_s1_cd
L_s1_ca:
    s_waitcnt vmcnt(8) lgkmcnt(0)
L_s1_cd:
    s_barrier
    s_add_u32 s5, s5, 1
    s_cmp_eq_u32 s4, 4
    s_cbranch_scc0 L_s1_nof1
    s_lshl_b32 s7, s2, 4
    s_add_u32 s6, s7, 327680
    v_lshl_add_u32 v2, v1, 12, s6
    v_mov_b32 v3, s5
    s_mov_b64 exec, 0xff
    global_store_dword v2, v3, s[36:37] sc1
    s_mov_b64 exec, -1
L_s1_nof1:
    ds_read_b128 v[22:25], v10 offset:33024
    v_lshlrev_b32 v108, 6, v8
    ds_read_b128 v[92:95], v108 offset:28928
    ds_read_b128 v[96:99], v108 offset:28944
    ds_read_b128 v[100:103], v108 offset:28960
    ds_read_b128 v[104:107], v108 offset:28976
    s_waitcnt lgkmcnt(0)
    v_pk_add_f32 v[92:93], v[92:93], v[94:95]
    v_pk_add_f32 v[96:97], v[96:97], v[98:99]
    v_pk_add_f32 v[100:101], v[100:101], v[102:103]
    v_pk_add_f32 v[104:105], v[104:105], v[106:107]
    v_pk_add_f32 v[92:93], v[92:93], v[96:97]
    v_pk_add_f32 v[100:101], v[100:101], v[104:105]
    v_pk_add_f32 v[90:91], v[92:93], v[100:101]
    v_mul_f32 v90, 0x3b000000, v90
    v_mul_f32 v91, 0x3b000000, v91
    v_fma_f32 v91, -v90, v90, v91
    v_max_f32 v91, 0, v91
    v_cvt_pk_bf16_f32 v108, v90, v91
    v_lshlrev_b32 v88, 16, v108
    v_and_b32 v108, s67, v108
    v_add_f32 v108, s66, v108
    v_cvt_pk_bf16_f32 v108, v108, v108
    v_lshlrev_b32 v108, 16, v108
    v_sqrt_f32 v108, v108
    s_nop 0
    v_cvt_pk_bf16_f32 v108, v108, v108
    v_lshlrev_b32 v112, 16, v108
    v_rcp_f32 v110, v112
    v_pk_add_f32 v[92:93], v[72:73], v[88:89] op_sel_hi:[1,0] neg_lo:[0,1] neg_hi:[0,1]
    v_pk_add_f32 v[94:95], v[74:75], v[88:89] op_sel_hi:[1,0] neg_lo:[0,1] neg_hi:[0,1]
    v_pk_add_f32 v[96:97], v[76:77], v[88:89] op_sel_hi:[1,0] neg_lo:[0,1] neg_hi:[0,1]
    v_pk_add_f32 v[98:99], v[78:79], v[88:89] op_sel_hi:[1,0] neg_lo:[0,1] neg_hi:[0,1]
    v_cvt_pk_bf16_f32 v100, v92, v93
    v_cvt_pk_bf16_f32 v101, v94, v95
    v_cvt_pk_bf16_f32 v102, v96, v97
    v_cvt_pk_bf16_f32 v103, v98, v99
    v_lshlrev_b32 v92, 16, v100
    v_and_b32 v93, s67, v100
    v_lshlrev_b32 v94, 16, v101
    v_and_b32 v95, s67, v101
    v_lshlrev_b32 v96, 16, v102
    v_and_b32 v97, s67, v102
    v_lshlrev_b32 v98, 16, v103
    v_and_b32 v99, s67, v103
    v_pk_mul_f32 v[92:93], v[92:93], v[110:111] op_sel_hi:[1,0]
    v_pk_mul_f32 v[94:95], v[94:95], v[110:111] op_sel_hi:[1,0]
    v_pk_mul_f32 v[96:97], v[96:97], v[110:111] op_sel_hi:[1,0]
    v_pk_mul_f32 v[98:99], v[98:99], v[110:111] op_sel_hi:[1,0]
    v_cvt_pk_bf16_f32 v100, v92, v93
    v_cvt_pk_bf16_f32 v101, v94, v95
    v_cvt_pk_bf16_f32 v102, v96, v97
    v_cvt_pk_bf16_f32 v103, v98, v99
    v_lshlrev_b32 v92, 16, v100
    v_and_b32 v93, s67, v100
    v_lshlrev_b32 v94, 16, v101
    v_and_b32 v95, s67, v101
    v_lshlrev_b32 v96, 16, v102
    v_and_b32 v97, s67, v102
    v_lshlrev_b32 v98, 16, v103
    v_and_b32 v99, s67, v103
    v_cvt_pk_f16_f32 v104, v92, v93
    v_cvt_pk_f16_f32 v105, v94, v95
    v_cvt_pk_f16_f32 v106, v96, v97
    v_cvt_pk_f16_f32 v107, v98, v99
    s_mul_i32 s42, s4, 1536
    s_add_u32 s42, s42, 35072
    v_mul_u32_u24 v2, 192, v8
    v_lshl_add_u32 v2, v9, 4, v2
    v_add_u32 v2, s42, v2
    ds_write_b128 v2, v[104:107]
    v_bfe_u32 v3, v1, 2, 2
    v_mul_u32_u24 v3, 192, v3
    v_lshrrev_b32 v4, 4, v1
    v_lshl_add_u32 v3, v4, 5, v3
    v_and_b32 v4, 3, v1
    v_lshl_add_u32 v3, v4, 3, v3
    v_add_u32 v3, s42, v3
    v_add_u32 v4, 1048576, v13
    s_waitcnt lgkmcnt(0)
    ds_read_b64_tr_b16 v[100:101], v3
    ds_read_b64_tr_b16 v[102:103], v3 offset:768
    v_lshlrev_b32 v80, 16, v22
    v_and_b32 v81, s67, v22
    v_lshlrev_b32 v82, 16, v23
    v_and_b32 v83, s67, v23
    v_lshlrev_b32 v84, 16, v24
    v_and_b32 v85, s67, v24
    v_lshlrev_b32 v86, 16, v25
    v_and_b32 v87, s67, v25
    v_pk_mul_f32 v[80:81], v[80:81], v[92:93]
    v_pk_mul_f32 v[82:83], v[82:83], v[94:95]
    v_pk_mul_f32 v[84:85], v[84:85], v[96:97]
    v_pk_mul_f32 v[86:87], v[86:87], v[98:99]
    s_cmp_eq_u32 s4, 4
    s_cbranch_scc1 L_s1_ya
    s_waitcnt vmcnt(0) lgkmcnt(0)
    s_branch L_s1_yd
L_s1_ya:
    s_waitcnt vmcnt(1) lgkmcnt(0)
L_s1_yd:
    global_store_dwordx4 v4, v[100:103], s[36:37] sc1
    v_cvt_pk_bf16_f32 v104, v80, v81
    v_cvt_pk_bf16_f32 v105, v82, v83
    v_cvt_pk_bf16_f32 v106, v84, v85
    v_cvt_pk_bf16_f32 v107, v86, v87
    v_lshlrev_b32 v80, 16, v104
    v_and_b32 v81, s67, v104
    v_lshlrev_b32 v82, 16, v105
    v_and_b32 v83, s67, v105
    v_lshlrev_b32 v84, 16, v106
    v_and_b32 v85, s67, v106
    v_lshlrev_b32 v86, 16, v107
    v_and_b32 v87, s67, v107
    s_waitcnt vmcnt(1)
    v_lshlrev_b32 v17, 16, v17
    v_lshlrev_b32 v26, 16, v26
    v_lshlrev_b32 v31, 16, v31
    v_mul_f32 v90, s62, v31
    v_fma_f32 v91, v31, s62, -v90
    v_fma_f32 v91, v31, s63, v91
    v_exp_f32 v31, v90
    v_mul_f32 v91, 0x3f317218, v91
    v_fma_f32 v31, v31, v91, v31
    v_mul_f32 v92, s62, v17
    v_fma_f32 v93, v17, s62, -v92
    v_fma_f32 v93, v17, s63, v93
    v_exp_f32 v17, v92
    v_mul_f32 v93, 0x3f317218, v93
    v_fma_f32 v17, v17, v93, v17
    v_cvt_pk_bf16_f32 v90, v31, v17
    v_lshlrev_b32 v31, 16, v90
    v_and_b32 v17, s67, v90
    v_mul_f32 v18, v17, v31
    v_mul_f32 v90, v26, v31
    v_mul_f32 v18, s62, v18
    v_mul_f32 v19, s64, v90
    v_fma_f32 v20, v90, s64, -v19
    v_fma_f32 v20, v90, s65, v20
    s_bfe_u32 s6, s4, 0x10001
    s_mul_i32 s6, s6, 34816
    s_add_u32 s6, s6, 27360
    s_and_b32 s7, s4, 1
    s_lshl_b32 s7, s7, 8
    s_add_u32 s6, s6, s7
    s_mov_b32 m0, s6
    s_cmp_ge_u32 s4, 4
    s_cbranch_scc1 L_k_roleB
    v_lshlrev_b32 v27, 16, v27
    v_lshlrev_b32 v28, 16, v28
    v_lshlrev_b32 v29, 16, v29
    v_lshlrev_b32 v30, 16, v30
    v_add_f32 v94, |v27|, |v28|
    v_add_f32 v95, |v29|, |v30|
    v_add_f32 v94, v94, v95
    s_nop 1
    v_add_f32_dpp v94, v94, v94 row_ror:1 row_mask:0xf bank_mask:0xf
    s_nop 1
    v_add_f32_dpp v94, v94, v94 row_ror:2 row_mask:0xf bank_mask:0xf
    s_nop 1
    v_add_f32_dpp v94, v94, v94 row_ror:4 row_mask:0xf bank_mask:0xf
    s_nop 1
    v_add_f32_dpp v94, v94, v94 row_ror:8 row_mask:0xf bank_mask:0xf
    v_mov_b32 v95, v94
    s_nop 1
    v_permlane16_swap_b32 v95, v94
    v_add_f32 v94, v94, v95
    v_mov_b32 v95, v94
    s_nop 1
    v_permlane32_swap_b32 v95, v94
    v_add_f32 v94, v94, v95
    v_mul_f32 v90, 0xc3000000, v18
    v_mul_f32 v91, 0x43000000, v19
    v_exp_f32 v90, v90
    v_fract_f32 v91, v91
    v_mov_b32 v92, 0x43000000
    v_fma_f32 v91, v20, v92, v91
    v_cos_f32 v32, v91
    v_sin_f32 v33, v91
    s_nop 0
    v_pk_mul_f32 v[32:33], v[32:33], v[90:91] op_sel_hi:[1,0]
    v_mul_f32 v90, 0xbf800000, v18
    v_mul_f32 v91, 0x3f800000, v19
    v_exp_f32 v90, v90
    v_fract_f32 v91, v91
    v_mov_b32 v92, 0x3f800000
    v_fma_f32 v91, v20, v92, v91
    v_cos_f32 v22, v91
    v_sin_f32 v23, v91
    s_nop 0
    v_pk_mul_f32 v[22:23], v[22:23], v[90:91] op_sel_hi:[1,0]
    v_add_f32 v21, v31, v31
    v_mul_f32 v94, v94, v21
    v_frexp_exp_i32_f32 v95, v94
    v_sub_u32 v96, 15, v95
    v_ldexp_f32 v21, v21, v96
    v_subrev_u32 v95, 15, v95
    v_mov_b32 v96, 1.0
    v_ldexp_f32 v96, v96, v95
    s_lshr_b32 s6, s4, 1
    s_lshl_b32 s6, s6, 2
    s_add_u32 s6, s6, 30208
    v_mov_b32 v97, s6
    s_mov_b64 exec, 1
    ds_write_b32 v97, v96
    s_mov_b64 exec, -1
    v_mul_f32 v104, v27, v21
    v_mul_f32 v105, v28, v21
    v_pk_mul_f32 v[110:111], v[22:23], v[22:23] op_sel:[0,0] op_sel_hi:[0,1]
    v_pk_fma_f32 v[110:111], v[22:23], v[22:23], v[110:111] op_sel:[1,1,0] op_sel_hi:[1,0,1] neg_lo:[1,0,0]
    v_pk_mul_f32 v[106:107], v[104:105], v[32:33] op_sel:[0,0] op_sel_hi:[0,1]
    v_pk_fma_f32 v[106:107], v[104:105], v[32:33], v[106:107] op_sel:[1,1,0] op_sel_hi:[1,0,1] neg_lo:[1,0,0]
    v_cvt_pk_f16_f32 v98, v104, -v105
    ds_write_addtid_b32 v98 offset:28704
    v_pk_mul_f32 v[112:113], v[110:111], v[22:23] op_sel:[0,0] op_sel_hi:[0,1]
    v_pk_fma_f32 v[112:113], v[110:111], v[22:23], v[112:113] op_sel:[1,1,0] op_sel_hi:[1,0,1] neg_lo:[1,0,0]
    v_pk_mul_f32 v[116:117], v[110:111], v[110:111] op_sel:[0,0] op_sel_hi:[0,1]
    v_pk_fma_f32 v[116:117], v[110:111], v[110:111], v[116:117] op_sel:[1,1,0] op_sel_hi:[1,0,1] neg_lo:[1,0,0]
    v_pk_mul_f32 v[118:119], v[116:117], v[22:23] op_sel:[0,0] op_sel_hi:[0,1]
    v_pk_fma_f32 v[118:119], v[116:117], v[22:23], v[118:119] op_sel:[1,1,0] op_sel_hi:[1,0,1] neg_lo:[1,0,0]
    v_pk_mul_f32 v[120:121], v[116:117], v[110:111] op_sel:[0,0] op_sel_hi:[0,1]
    v_pk_fma_f32 v[120:121], v[116:117], v[110:111], v[120:121] op_sel:[1,1,0] op_sel_hi:[1,0,1] neg_lo:[1,0,0]
    v_pk_mul_f32 v[122:123], v[116:117], v[112:113] op_sel:[0,0] op_sel_hi:[0,1]
    v_pk_fma_f32 v[122:123], v[116:117], v[112:113], v[122:123] op_sel:[1,1,0] op_sel_hi:[1,0,1] neg_lo:[1,0,0]
    v_pk_mul_f32 v[124:125], v[104:105], v[22:23] op_sel:[0,0] op_sel_hi:[0,1]
    v_pk_fma_f32 v[124:125], v[104:105], v[22:23], v[124:125] op_sel:[1,1,0] op_sel_hi:[1,0,1] neg_lo:[1,0,0]
    v_cvt_pk_f16_f32 v99, v124, -v125
    ds_write_addtid_b32 v99 offset:29248
    v_pk_mul_f32 v[126:127], v[104:105], v[110:111] op_sel:[0,0] op_sel_hi:[0,1]
    v_pk_fma_f32 v[126:127], v[104:105], v[110:111], v[126:127] op_sel:[1,1,0] op_sel_hi:[1,0,1] neg_lo:[1,0,0]
    v_cvt_pk_f16_f32 v100, v126, -v127
    ds_write_addtid_b32 v100 offset:29792
    v_pk_mul_f32 v[124:125], v[104:105], v[112:113] op_sel:[0,0] op_sel_hi:[0,1]
    v_pk_fma_f32 v[124:125], v[104:105], v[112:113], v[124:125] op_sel:[1,1,0] op_sel_hi:[1,0,1] neg_lo:[1,0,0]
    v_cvt_pk_f16_f32 v101, v124, -v125
    ds_write_addtid_b32 v101 offset:30336
    v_pk_mul_f32 v[126:127], v[104:105], v[116:117] op_sel:[0,0] op_sel_hi:[0,1]
    v_pk_fma_f32 v[126:127], v[104:105], v[116:117], v[126:127] op_sel:[1,1,0] op_sel_hi:[1,0,1] neg_lo:[1,0,0]
    v_cvt_pk_f16_f32 v98, v126, -v127
    ds_write_addtid_b32 v98 offset:30880
    v_pk_mul_f32 v[124:125], v[104:105], v[118:119] op_sel:[0,0] op_sel_hi:[0,1]
    v_pk_fma_f32 v[124:125], v[104:105], v[118:119], v[124:125] op_sel:[1,1,0] op_sel_hi:[1,0,1] neg_lo:[1,0,0]
    v_cvt_pk_f16_f32 v99, v124, -v125
    ds_write_addtid_b32 v99 offset:31424
    v_pk_mul_f32 v[126:127], v[104:105], v[120:121] op_sel:[0,0] op_sel_hi:[0,1]
    v_pk_fma_f32 v[126:127], v[104:105], v[120:121], v[126:127] op_sel:[1,1,0] op_sel_hi:[1,0,1] neg_lo:[1,0,0]
    v_cvt_pk_f16_f32 v100, v126, -v127
    ds_write_addtid_b32 v100 offset:31968
    v_pk_mul_f32 v[124:125], v[104:105], v[122:123] op_sel:[0,0] op_sel_hi:[0,1]
    v_pk_fma_f32 v[124:125], v[104:105], v[122:123], v[124:125] op_sel:[1,1,0] op_sel_hi:[1,0,1] neg_lo:[1,0,0]
    v_cvt_pk_f16_f32 v101, v124, -v125
    ds_write_addtid_b32 v101 offset:32512
    v_cvt_pk_f16_f32 v98, v106, -v107
    ds_write_addtid_b32 v98 offset:33056
    v_pk_mul_f32 v[104:105], v[106:107], v[32:33] op_sel:[0,0] op_sel_hi:[0,1]
    v_pk_fma_f32 v[104:105], v[106:107], v[32:33], v[104:105] op_sel:[1,1,0] op_sel_hi:[1,0,1] neg_lo:[1,0,0]
    v_pk_mul_f32 v[126:127], v[106:107], v[22:23] op_sel:[0,0] op_sel_hi:[0,1]
    v_pk_fma_f32 v[126:127], v[106:107], v[22:23], v[126:127] op_sel:[1,1,0] op_sel_hi:[1,0,1] neg_lo:[1,0,0]
    v_cvt_pk_f16_f32 v99, v126, -v127
    ds_write_addtid_b32 v99 offset:33600
    v_pk_mul_f32 v[124:125], v[106:107], v[110:111] op_sel:[0,0] op_sel_hi:[0,1]
    v_pk_fma_f32 v[124:125], v[106:107], v[110:111], v[124:125] op_sel:[1,1,0] op_sel_hi:[1,0,1] neg_lo:[1,0,0]
    v_cvt_pk_f16_f32 v100, v124, -v125
    ds_write_addtid_b32 v100 offset:34144
    v_pk_mul_f32 v[126:127], v[106:107], v[112:113] op_sel:[0,0] op_sel_hi:[0,1]
    v_pk_fma_f32 v[126:127], v[106:107], v[112:113], v[126:127] op_sel:[1,1,0] op_sel_hi:[1,0,1] neg_lo:[1,0,0]
    v_cvt_pk_f16_f32 v101, v126, -v127
    ds_write_addtid_b32 v101 offset:34688
    v_pk_mul_f32 v[124:125], v[106:107], v[116:117] op_sel:[0,0] op_sel_hi:[0,1]
    v_pk_fma_f32 v[124:125], v[106:107], v[116:117], v[124:125] op_sel:[1,1,0] op_sel_hi:[1,0,1] neg_lo:[1,0,0]
    v_cvt_pk_f16_f32 v98, v124, -v125
    ds_write_addtid_b32 v98 offset:35232
    v_pk_mul_f32 v[126:127], v[106:107], v[118:119] op_sel:[0,0] op_sel_hi:[0,1]
    v_pk_fma_f32 v[126:127], v[106:107], v[118:119], v[126:127] op_sel:[1,1,0] op_sel_hi:[1,0,1] neg_lo:[1,0,0]
    v_cvt_pk_f16_f32 v99, v126, -v127
    ds_write_addtid_b32 v99 offset:35776
    v_pk_mul_f32 v[124:125], v[106:107], v[120:121] op_sel:[0,0] op_sel_hi:[0,1]
    v_pk_fma_f32 v[124:125], v[106:107], v[120:121], v[124:125] op_sel:[1,1,0] op_sel_hi:[1,0,1] neg_lo:[1,0,0]
    v_cvt_pk_f16_f32 v100, v124, -v125
    ds_write_addtid_b32 v100 offset:36320
    v_pk_mul_f32 v[126:127], v[106:107], v[122:123] op_sel:[0,0] op_sel_hi:[0,1]
    v_pk_fma_f32 v[126:127], v[106:107], v[122:123], v[126:127] op_sel:[1,1,0] op_sel_hi:[1,0,1] neg_lo:[1,0,0]
    v_cvt_pk_f16_f32 v101, v126, -v127
    ds_write_addtid_b32 v101 offset:36864
    v_cvt_pk_f16_f32 v98, v104, -v105
    ds_write_addtid_b32 v98 offset:37408
    v_pk_mul_f32 v[106:107], v[104:105], v[32:33] op_sel:[0,0] op_sel_hi:[0,1]
    v_pk_fma_f32 v[106:107], v[104:105], v[32:33], v[106:107] op_sel:[1,1,0] op_sel_hi:[1,0,1] neg_lo:[1,0,0]
    v_pk_mul_f32 v[124:125], v[104:105], v[110:111] op_sel:[0,0] op_sel_hi:[0,1]
    v_pk_fma_f32 v[124:125], v[104:105], v[110:111], v[124:125] op_sel:[1,1,0] op_sel_hi:[1,0,1] neg_lo:[1,0,0]
    v_cvt_pk_f16_f32 v99, v124, -v125
    ds_write_addtid_b32 v99 offset:37952
    v_pk_mul_f32 v[126:127], v[104:105], v[116:117] op_sel:[0,0] op_sel_hi:[0,1]
    v_pk_fma_f32 v[126:127], v[104:105], v[116:117], v[126:127] op_sel:[1,1,0] op_sel_hi:[1,0,1] neg_lo:[1,0,0]
    v_cvt_pk_f16_f32 v100, v126, -v127
    ds_write_addtid_b32 v100 offset:38496
    v_pk_mul_f32 v[124:125], v[104:105], v[120:121] op_sel:[0,0] op_sel_hi:[0,1]
    v_pk_fma_f32 v[124:125], v[104:105], v[120:121], v[124:125] op_sel:[1,1,0] op_sel_hi:[1,0,1] neg_lo:[1,0,0]
    v_cvt_pk_f16_f32 v101, v124, -v125
    ds_write_addtid_b32 v101 offset:39040
    v_cvt_pk_f16_f32 v98, v106, -v107
    ds_write_addtid_b32 v98 offset:39584
    v_pk_mul_f32 v[104:105], v[106:107], v[32:33] op_sel:[0,0] op_sel_hi:[0,1]
    v_pk_fma_f32 v[104:105], v[106:107], v[32:33], v[104:105] op_sel:[1,1,0] op_sel_hi:[1,0,1] neg_lo:[1,0,0]
    v_pk_mul_f32 v[126:127], v[106:107], v[110:111] op_sel:[0,0] op_sel_hi:[0,1]
    v_pk_fma_f32 v[126:127], v[106:107], v[110:111], v[126:127] op_sel:[1,1,0] op_sel_hi:[1,0,1] neg_lo:[1,0,0]
    v_cvt_pk_f16_f32 v99, v126, -v127
    ds_write_addtid_b32 v99 offset:40128
    v_pk_mul_f32 v[124:125], v[106:107], v[116:117] op_sel:[0,0] op_sel_hi:[0,1]
    v_pk_fma_f32 v[124:125], v[106:107], v[116:117], v[124:125] op_sel:[1,1,0] op_sel_hi:[1,0,1] neg_lo:[1,0,0]
    v_cvt_pk_f16_f32 v100, v124, -v125
    ds_write_addtid_b32 v100 offset:40672
    v_pk_mul_f32 v[126:127], v[106:107], v[120:121] op_sel:[0,0] op_sel_hi:[0,1]
    v_pk_fma_f32 v[126:127], v[106:107], v[120:121], v[126:127] op_sel:[1,1,0] op_sel_hi:[1,0,1] neg_lo:[1,0,0]
    v_cvt_pk_f16_f32 v101, v126, -v127
    ds_write_addtid_b32 v101 offset:41216
    v_cvt_pk_f16_f32 v98, v104, -v105
    ds_write_addtid_b32 v98 offset:41760
    v_pk_mul_f32 v[106:107], v[104:105], v[32:33] op_sel:[0,0] op_sel_hi:[0,1]
    v_pk_fma_f32 v[106:107], v[104:105], v[32:33], v[106:107] op_sel:[1,1,0] op_sel_hi:[1,0,1] neg_lo:[1,0,0]
    v_pk_mul_f32 v[124:125], v[104:105], v[116:117] op_sel:[0,0] op_sel_hi:[0,1]
    v_pk_fma_f32 v[124:125], v[104:105], v[116:117], v[124:125] op_sel:[1,1,0] op_sel_hi:[1,0,1] neg_lo:[1,0,0]
    v_cvt_pk_f16_f32 v99, v124, -v125
    ds_write_addtid_b32 v99 offset:42304
    v_cvt_pk_f16_f32 v100, v106, -v107
    ds_write_addtid_b32 v100 offset:42848
    v_pk_mul_f32 v[104:105], v[106:107], v[32:33] op_sel:[0,0] op_sel_hi:[0,1]
    v_pk_fma_f32 v[104:105], v[106:107], v[32:33], v[104:105] op_sel:[1,1,0] op_sel_hi:[1,0,1] neg_lo:[1,0,0]
    v_pk_mul_f32 v[126:127], v[106:107], v[116:117] op_sel:[0,0] op_sel_hi:[0,1]
    v_pk_fma_f32 v[126:127], v[106:107], v[116:117], v[126:127] op_sel:[1,1,0] op_sel_hi:[1,0,1] neg_lo:[1,0,0]
    v_cvt_pk_f16_f32 v101, v126, -v127
    ds_write_addtid_b32 v101 offset:43392
    v_cvt_pk_f16_f32 v98, v104, -v105
    ds_write_addtid_b32 v98 offset:43936
    v_pk_mul_f32 v[106:107], v[104:105], v[32:33] op_sel:[0,0] op_sel_hi:[0,1]
    v_pk_fma_f32 v[106:107], v[104:105], v[32:33], v[106:107] op_sel:[1,1,0] op_sel_hi:[1,0,1] neg_lo:[1,0,0]
    v_pk_mul_f32 v[124:125], v[104:105], v[116:117] op_sel:[0,0] op_sel_hi:[0,1]
    v_pk_fma_f32 v[124:125], v[104:105], v[116:117], v[124:125] op_sel:[1,1,0] op_sel_hi:[1,0,1] neg_lo:[1,0,0]
    v_cvt_pk_f16_f32 v99, v124, -v125
    ds_write_addtid_b32 v99 offset:44480
    v_cvt_pk_f16_f32 v100, v106, -v107
    ds_write_addtid_b32 v100 offset:45024
    v_pk_mul_f32 v[104:105], v[106:107], v[32:33] op_sel:[0,0] op_sel_hi:[0,1]
    v_pk_fma_f32 v[104:105], v[106:107], v[32:33], v[104:105] op_sel:[1,1,0] op_sel_hi:[1,0,1] neg_lo:[1,0,0]
    v_pk_mul_f32 v[126:127], v[106:107], v[116:117] op_sel:[0,0] op_sel_hi:[0,1]
    v_pk_fma_f32 v[126:127], v[106:107], v[116:117], v[126:127] op_sel:[1,1,0] op_sel_hi:[1,0,1] neg_lo:[1,0,0]
    v_cvt_pk_f16_f32 v101, v126, -v127
    ds_write_addtid_b32 v101 offset:45568
    v_cvt_pk_f16_f32 v98, v104, -v105
    ds_write_addtid_b32 v98 offset:46112
    v_pk_mul_f32 v[106:107], v[104:105], v[32:33] op_sel:[0,0] op_sel_hi:[0,1]
    v_pk_fma_f32 v[106:107], v[104:105], v[32:33], v[106:107] op_sel:[1,1,0] op_sel_hi:[1,0,1] neg_lo:[1,0,0]
    v_cvt_pk_f16_f32 v99, v106, -v107
    ds_write_addtid_b32 v99 offset:46656
    v_pk_mul_f32 v[104:105], v[106:107], v[32:33] op_sel:[0,0] op_sel_hi:[0,1]
    v_pk_fma_f32 v[104:105], v[106:107], v[32:33], v[104:105] op_sel:[1,1,0] op_sel_hi:[1,0,1] neg_lo:[1,0,0]
    v_cvt_pk_f16_f32 v100, v104, -v105
    ds_write_addtid_b32 v100 offset:47200
    v_pk_mul_f32 v[106:107], v[104:105], v[32:33] op_sel:[0,0] op_sel_hi:[0,1]
    v_pk_fma_f32 v[106:107], v[104:105], v[32:33], v[106:107] op_sel:[1,1,0] op_sel_hi:[1,0,1] neg_lo:[1,0,0]
    v_cvt_pk_f16_f32 v101, v106, -v107
    ds_write_addtid_b32 v101 offset:47744
    v_pk_mul_f32 v[104:105], v[106:107], v[32:33] op_sel:[0,0] op_sel_hi:[0,1]
    v_pk_fma_f32 v[104:105], v[106:107], v[32:33], v[104:105] op_sel:[1,1,0] op_sel_hi:[1,0,1] neg_lo:[1,0,0]
    v_cvt_pk_f16_f32 v98, v104, -v105
    ds_write_addtid_b32 v98 offset:48288
    v_pk_mul_f32 v[106:107], v[104:105], v[32:33] op_sel:[0,0] op_sel_hi:[0,1]
    v_pk_fma_f32 v[106:107], v[104:105], v[32:33], v[106:107] op_sel:[1,1,0] op_sel_hi:[1,0,1] neg_lo:[1,0,0]
    v_cvt_pk_f16_f32 v99, v106, -v107
    ds_write_addtid_b32 v99 offset:48832
    v_pk_mul_f32 v[104:105], v[106:107], v[32:33] op_sel:[0,0] op_sel_hi:[0,1]
    v_pk_fma_f32 v[104:105], v[106:107], v[32:33], v[104:105] op_sel:[1,1,0] op_sel_hi:[1,0,1] neg_lo:[1,0,0]
    v_cvt_pk_f16_f32 v100, v104, -v105
    ds_write_addtid_b32 v100 offset:49376
    v_pk_mul_f32 v[106:107], v[104:105], v[32:33] op_sel:[0,0] op_sel_hi:[0,1]
    v_pk_fma_f32 v[106:107], v[104:105], v[32:33], v[106:107] op_sel:[1,1,0] op_sel_hi:[1,0,1] neg_lo:[1,0,0]
    v_cvt_pk_f16_f32 v101, v106, -v107
    ds_write_addtid_b32 v101 offset:49920
    v_pk_mul_f32 v[104:105], v[106:107], v[32:33] op_sel:[0,0] op_sel_hi:[0,1]
    v_pk_fma_f32 v[104:105], v[106:107], v[32:33], v[104:105] op_sel:[1,1,0] op_sel_hi:[1,0,1] neg_lo:[1,0,0]
    v_cvt_pk_f16_f32 v98, v104, -v105
    ds_write_addtid_b32 v98 offset:50464
    s_waitcnt lgkmcnt(0)
    s_branch L_k_bb
L_k_roleB:
    v_mul_f32 v90, 0xc1000000, v18
    v_mul_f32 v91, 0x41000000, v19
    v_exp_f32 v90, v90
    v_fract_f32 v91, v91
    v_mov_b32 v92, 0x41000000
    v_fma_f32 v91, v20, v92, v91
    v_cos_f32 v24, v91
    v_sin_f32 v25, v91
    s_nop 0
    v_pk_mul_f32 v[24:25], v[24:25], v[90:91] op_sel_hi:[1,0]
    v_mov_b32 v98, 0x00003c00
    ds_write_addtid_b32 v98 offset:20000
    v_cvt_pk_f16_f32 v99, v24, v25
    ds_write_addtid_b32 v99 offset:20544
    v_pk_mul_f32 v[34:35], v[24:25], v[24:25] op_sel:[0,0] op_sel_hi:[0,1]
    v_pk_fma_f32 v[34:35], v[24:25], v[24:25], v[34:35] op_sel:[1,1,0] op_sel_hi:[1,0,1] neg_lo:[1,0,0]
    v_cvt_pk_f16_f32 v100, v34, v35
    ds_write_addtid_b32 v100 offset:21088
    v_pk_mul_f32 v[102:103], v[34:35], v[24:25] op_sel:[0,0] op_sel_hi:[0,1]
    v_pk_fma_f32 v[102:103], v[34:35], v[24:25], v[102:103] op_sel:[1,1,0] op_sel_hi:[1,0,1] neg_lo:[1,0,0]
    v_cvt_pk_f16_f32 v101, v102, v103
    ds_write_addtid_b32 v101 offset:21632
    v_pk_mul_f32 v[34:35], v[102:103], v[24:25] op_sel:[0,0] op_sel_hi:[0,1]
    v_pk_fma_f32 v[34:35], v[102:103], v[24:25], v[34:35] op_sel:[1,1,0] op_sel_hi:[1,0,1] neg_lo:[1,0,0]
    v_cvt_pk_f16_f32 v98, v34, v35
    ds_write_addtid_b32 v98 offset:22176
    v_pk_mul_f32 v[102:103], v[34:35], v[24:25] op_sel:[0,0] op_sel_hi:[0,1]
    v_pk_fma_f32 v[102:103], v[34:35], v[24:25], v[102:103] op_sel:[1,1,0] op_sel_hi:[1,0,1] neg_lo:[1,0,0]
    v_cvt_pk_f16_f32 v99, v102, v103
    ds_write_addtid_b32 v99 offset:22720
    v_pk_mul_f32 v[34:35], v[102:103], v[24:25] op_sel:[0,0] op_sel_hi:[0,1]
    v_pk_fma_f32 v[34:35], v[102:103], v[24:25], v[34:35] op_sel:[1,1,0] op_sel_hi:[1,0,1] neg_lo:[1,0,0]
    v_cvt_pk_f16_f32 v100, v34, v35
    ds_write_addtid_b32 v100 offset:23264
    v_pk_mul_f32 v[102:103], v[34:35], v[24:25] op_sel:[0,0] op_sel_hi:[0,1]
    v_pk_fma_f32 v[102:103], v[34:35], v[24:25], v[102:103] op_sel:[1,1,0] op_sel_hi:[1,0,1] neg_lo:[1,0,0]
    v_cvt_pk_f16_f32 v101, v102, v103
    ds_write_addtid_b32 v101 offset:23808
    v_pk_mul_f32 v[34:35], v[102:103], v[24:25] op_sel:[0,0] op_sel_hi:[0,1]
    v_pk_fma_f32 v[34:35], v[102:103], v[24:25], v[34:35] op_sel:[1,1,0] op_sel_hi:[1,0,1] neg_lo:[1,0,0]
    v_cvt_pk_f16_f32 v98, v34, v35
    ds_write_addtid_b32 v98 offset:24352
    v_pk_mul_f32 v[102:103], v[34:35], v[24:25] op_sel:[0,0] op_sel_hi:[0,1]
    v_pk_fma_f32 v[102:103], v[34:35], v[24:25], v[102:103] op_sel:[1,1,0] op_sel_hi:[1,0,1] neg_lo:[1,0,0]
    v_cvt_pk_f16_f32 v99, v102, v103
    ds_write_addtid_b32 v99 offset:24896
    v_pk_mul_f32 v[34:35], v[102:103], v[24:25] op_sel:[0,0] op_sel_hi:[0,1]
    v_pk_fma_f32 v[34:35], v[102:103], v[24:25], v[34:35] op_sel:[1,1,0] op_sel_hi:[1,0,1] neg_lo:[1,0,0]
    v_cvt_pk_f16_f32 v100, v34, v35
    ds_write_addtid_b32 v100 offset:25440
    v_pk_mul_f32 v[102:103], v[34:35], v[24:25] op_sel:[0,0] op_sel_hi:[0,1]
    v_pk_fma_f32 v[102:103], v[34:35], v[24:25], v[102:103] op_sel:[1,1,0] op_sel_hi:[1,0,1] neg_lo:[1,0,0]
    v_cvt_pk_f16_f32 v101, v102, v103
    ds_write_addtid_b32 v101 offset:25984
    v_pk_mul_f32 v[34:35], v[102:103], v[24:25] op_sel:[0,0] op_sel_hi:[0,1]
    v_pk_fma_f32 v[34:35], v[102:103], v[24:25], v[34:35] op_sel:[1,1,0] op_sel_hi:[1,0,1] neg_lo:[1,0,0]
    v_cvt_pk_f16_f32 v98, v34, v35
    ds_write_addtid_b32 v98 offset:26528
    v_pk_mul_f32 v[102:103], v[34:35], v[24:25] op_sel:[0,0] op_sel_hi:[0,1]
    v_pk_fma_f32 v[102:103], v[34:35], v[24:25], v[102:103] op_sel:[1,1,0] op_sel_hi:[1,0,1] neg_lo:[1,0,0]
    v_cvt_pk_f16_f32 v99, v102, v103
    ds_write_addtid_b32 v99 offset:27072
    v_pk_mul_f32 v[34:35], v[102:103], v[24:25] op_sel:[0,0] op_sel_hi:[0,1]
    v_pk_fma_f32 v[34:35], v[102:103], v[24:25], v[34:35] op_sel:[1,1,0] op_sel_hi:[1,0,1] neg_lo:[1,0,0]
    v_cvt_pk_f16_f32 v100, v34, v35
    ds_write_addtid_b32 v100 offset:27616
    v_pk_mul_f32 v[102:103], v[34:35], v[24:25] op_sel:[0,0] op_sel_hi:[0,1]
    v_pk_fma_f32 v[102:103], v[34:35], v[24:25], v[102:103] op_sel:[1,1,0] op_sel_hi:[1,0,1] neg_lo:[1,0,0]
    v_cvt_pk_f16_f32 v101, v102, v103
    ds_write_addtid_b32 v101 offset:28160
    s_cmp_eq_u32 s4, 4
    s_cbranch_scc0 L_k_nof1p
    s_mov_b32 s60, 0
L_f1_1:
    global_load_dword v50, v49, s[36:37] offset:0 sc1
    global_load_dword v51, v49, s[36:37] offset:1024 sc1
    global_load_dword v52, v49, s[36:37] offset:2048 sc1
    global_load_dword v53, v49, s[36:37] offset:3072 sc1
    s_waitcnt vmcnt(0)
    v_xor_b32 v2, s5, v50
    v_xor_b32 v3, s5, v51
    v_or_b32 v2, v2, v3
    v_xor_b32 v3, s5, v52
    v_or_b32 v2, v2, v3
    v_xor_b32 v3, s5, v53
    v_or_b32 v2, v2, v3
    v_cmp_ne_u32 vcc, 0, v2
    s_nop 3
    s_cbranch_vccz L_f1ok_2
    s_mov_b64 exec, vcc
    s_add_u32 s60, s60, 1
    s_cmp_lt_u32 s60, 32768
    s_cbranch_scc1 L_f1_1
L_f1ok_2:
    s_mov_b64 exec, -1
L_k_nof1p:
    s_waitcnt lgkmcnt(0)
L_k_bb:
    s_barrier
    s_cmp_lt_u32 s4, 4
    s_cbranch_scc1 L_k_nog
    global_load_dwordx4 v[128:131], v62, s[36:37] sc1
    global_load_dwordx4 v[132:135], v62, s[36:37] offset:16 sc1
L_k_nog:
    s_cmp_ge_u32 s4, 6
    s_cbranch_scc1 L_k_nomf
    ds_read_b128 v[136:139], v16 offset:0
    ds_read_b128 v[168:171], v36 offset:0
    ds_read_b128 v[140:143], v16 offset:64
    ds_read_b128 v[172:175], v36 offset:64
    ds_read_b128 v[144:147], v16 offset:128
    ds_read_b128 v[176:179], v36 offset:128
    ds_read_b128 v[148:151], v16 offset:192
    ds_read_b128 v[180:183], v36 offset:192
    ds_read_b128 v[152:155], v16 offset:256
    ds_read_b128 v[184:187], v36 offset:256
    ds_read_b128 v[156:159], v16 offset:320
    ds_read_b128 v[188:191], v36 offset:320
    ds_read_b128 v[160:163], v16 offset:384
    ds_read_b128 v[192:195], v36 offset:384
    ds_read_b128 v[164:167], v16 offset:448
    ds_read_b128 v[196:199], v36 offset:448
    v_add_u32 v2, v14, v15
    v_add_u32 v3, v2, v15
    v_add_u32 v4, v3, v15
    s_waitcnt lgkmcnt(14)
    v_mfma_f32_16x16x32_f16 v[20:23], v[136:139], v[168:171], 0
    s_waitcnt lgkmcnt(12)
    v_mfma_f32_16x16x32_f16 v[20:23], v[140:143], v[172:175], v[20:23]
    s_waitcnt lgkmcnt(10)
    v_mfma_f32_16x16x32_f16 v[20:23], v[144:147], v[176:179], v[20:23]
    s_waitcnt lgkmcnt(8)
    v_mfma_f32_16x16x32_f16 v[20:23], v[148:151], v[180:183], v[20:23]
    s_waitcnt lgkmcnt(6)
    v_mfma_f32_16x16x32_f16 v[20:23], v[152:155], v[184:187], v[20:23]
    s_waitcnt lgkmcnt(4)
    v_mfma_f32_16x16x32_f16 v[20:23], v[156:159], v[188:191], v[20:23]
    s_waitcnt lgkmcnt(2)
    v_mfma_f32_16x16x32_f16 v[20:23], v[160:163], v[192:195], v[20:23]
    s_waitcnt lgkmcnt(0)
    v_mfma_f32_16x16x32_f16 v[20:23], v[164:167], v[196:199], v[20:23]
    s_nop 7
    v_cvt_pk_f16_f32 v136, v20, v21
    v_cvt_pk_f16_f32 v137, v22, v23
    ds_write_b16 v14, v136
    ds_write_b16_d16_hi v2, v136
    ds_write_b16 v3, v137
    ds_write_b16_d16_hi v4, v137
L_k_nomf:
    s_waitcnt lgkmcnt(0)
    s_barrier
    s_cmp_ge_u32 s4, 4
    s_cbranch_scc1 L_k_noexp
    ds_read_u16 v14, v38 offset:25856
    ds_read_u16 v15, v39 offset:25856
    ds_read_u16 v16, v40 offset:25856
    ds_read_u16 v17, v41 offset:25856
    ds_read_u16 v18, v42 offset:25856
    ds_read_u16 v19, v43 offset:25856
    ds_read_u16 v20, v44 offset:25856
    ds_read_u16 v21, v45 offset:25856
    ds_read_u16 v22, v46 offset:25856
    ds_read_u16 v23, v47 offset:25856
    ds_read_u16 v24, v38 offset:27392
    ds_read_u16 v25, v39 offset:27392
    ds_read_u16 v26, v40 offset:27392
    ds_read_u16 v27, v41 offset:27392
    ds_read_u16 v28, v42 offset:27392
    ds_read_u16 v29, v43 offset:27392
    ds_read_u16 v30, v44 offset:27392
    ds_read_u16 v31, v45 offset:27392
    ds_read_u16 v32, v46 offset:27392
    ds_read_u16 v33, v47 offset:27392
    s_waitcnt lgkmcnt(10)
    v_lshl_or_b32 v92, v16, 16, v15
    v_lshl_or_b32 v93, v18, 16, v17
    v_lshl_or_b32 v94, v20, 16, v19
    v_lshl_or_b32 v95, v22, 16, v21
    v_lshl_or_b32 v96, v15, 16, v14
    v_lshl_or_b32 v97, v17, 16, v16
    v_lshl_or_b32 v98, v19, 16, v18
    v_lshl_or_b32 v99, v21, 16, v20
    ds_write_b128 v37, v[92:95] offset:0
    ds_write_b128 v37, v[96:99] offset:4160
    s_cmp_eq_u32 s4, 0
    s_cbranch_scc0 L_tail_3
    v_lshl_or_b32 v3, v23, 16, v22
    v_mov_b32 v2, 4096
    s_mov_b64 exec, 1
    ds_write_b32 v2, v23 offset:0
    ds_write_b32 v2, v3 offset:4160
    s_mov_b64 exec, -1
L_tail_3:
    s_waitcnt lgkmcnt(2)
    v_lshl_or_b32 v92, v26, 16, v25
    v_lshl_or_b32 v93, v28, 16, v27
    v_lshl_or_b32 v94, v30, 16, v29
    v_lshl_or_b32 v95, v32, 16, v31
    v_lshl_or_b32 v96, v25, 16, v24
    v_lshl_or_b32 v97, v27, 16, v26
    v_lshl_or_b32 v98, v29, 16, v28
    v_lshl_or_b32 v99, v31, 16, v30
    ds_write_b128 v37, v[92:95] offset:8320
    ds_write_b128 v37, v[96:99] offset:12480
    s_cmp_eq_u32 s4, 0
    s_cbranch_scc0 L_tail_4
    v_lshl_or_b32 v3, v33, 16, v32
    v_mov_b32 v2, 4096
    s_mov_b64 exec, 1
    ds_write_b32 v2, v33 offset:8320
    ds_write_b32 v2, v3 offset:12480
    s_mov_b64 exec, -1
L_tail_4:
    s_branch L_k_bd
L_k_noexp:
    s_mov_b32 s60, 0
    s_branch L_uf_7
L_u_5:
    global_load_dwordx4 v[128:131], v62, s[36:37] sc1
    global_load_dwordx4 v[132:135], v62, s[36:37] offset:16 sc1
L_uf_7:
    s_waitcnt vmcnt(0)
    v_max_u32 v2, v128, v129
    v_max3_u32 v2, v2, v130, v131
    v_max3_u32 v2, v2, v132, v133
    v_max3_u32 v2, v2, v134, v135
    v_cmp_eq_u32 vcc, -1, v2
    s_nop 3
    s_cbranch_vccz L_uok_6
    s_mov_b64 exec, vcc
    s_add_u32 s60, s60, 1
    s_cmp_lt_u32 s60, 32768
    s_cbranch_scc1 L_u_5
L_uok_6:
    s_mov_b64 exec, -1
    ds_write_b128 v63, v[128:131] offset:17152
    ds_write_b128 v63, v[132:135] offset:21760
L_k_bd:
    s_waitcnt lgkmcnt(0)
    s_barrier
    s_cmp_ge_u32 s4, 4
    s_cbranch_scc1 L_c_roleB
    global_load_dword v6, v114, s[44:45]
    ds_read_b128 v[156:159], v70 offset:192
    ds_read2_b32 v[92:93], v66 offset0:240 offset1:241
    ds_read2_b32 v[94:95], v66 offset0:242 offset1:243
    ds_read_b128 v[160:163], v70 offset:704
    ds_read2_b32 v[96:97], v66 offset0:112 offset1:113
    ds_read2_b32 v[98:99], v66 offset0:114 offset1:115
    ds_read_b128 v[164:167], v70 offset:1216
    ds_read2_b32 v[100:101], v67 offset0:240 offset1:241
    ds_read2_b32 v[102:103], v67 offset0:242 offset1:243
    ds_read_b128 v[168:171], v70 offset:1728
    ds_read2_b32 v[104:105], v67 offset0:112 offset1:113
    ds_read2_b32 v[106:107], v67 offset0:114 offset1:115
    ds_read_b128 v[172:175], v70 offset:2240
    ds_read2_b32 v[108:109], v68 offset0:240 offset1:241
    ds_read2_b32 v[110:111], v68 offset0:242 offset1:243
    s_waitcnt lgkmcnt(12)
    v_mfma_f32_16x16x32_f16 v[16:19], v[92:95], v[156:159], 0
    ds_read_b128 v[176:179], v70 offset:2752
    ds_read2_b32 v[112:113], v68 offset0:112 offset1:113
    ds_read2_b32 v[114:115], v68 offset0:114 offset1:115
    s_waitcnt lgkmcnt(12)
    v_mfma_f32_16x16x32_f16 v[20:23], v[92:95], v[160:163], 0
    ds_read_b128 v[180:183], v70 offset:3264
    v_mfma_f32_16x16x32_f16 v[20:23], v[96:99], v[156:159], v[20:23]
    ds_read2_b32 v[116:117], v69 offset0:240 offset1:241
    v_mfma_f32_16x16x32_f16 v[24:27], v[96:99], v[160:163], 0
    ds_read2_b32 v[118:119], v69 offset0:242 offset1:243
    s_waitcnt lgkmcnt(12)
    v_mfma_f32_16x16x32_f16 v[24:27], v[92:95], v[164:167], v[24:27]
    ds_read_b128 v[184:187], v70 offset:3776
    v_mfma_f32_16x16x32_f16 v[28:31], v[96:99], v[164:167], 0
    ds_read2_b32 v[120:121], v69 offset0:112 offset1:113
    v_mfma_f32_16x16x32_f16 v[24:27], v[100:103], v[156:159], v[24:27]
    ds_read2_b32 v[122:123], v69 offset0:114 offset1:115
    v_mfma_f32_16x16x32_f16 v[28:31], v[100:103], v[160:163], v[28:31]
    v_mfma_f32_16x16x32_f16 v[32:35], v[100:103], v[164:167], 0
    s_waitcnt lgkmcnt(12)
    v_mfma_f32_16x16x32_f16 v[28:31], v[92:95], v[168:171], v[28:31]
    ds_read_b128 v[188:191], v70 offset:128
    v_mfma_f32_16x16x32_f16 v[32:35], v[96:99], v[168:171], v[32:35]
    ds_read2_b32 v[124:125], v66 offset0:224 offset1:225
    v_mfma_f32_16x16x32_f16 v[36:39], v[100:103], v[168:171], 0
    ds_read2_b32 v[126:127], v66 offset0:226 offset1:227
    v_mfma_f32_16x16x32_f16 v[28:31], v[104:107], v[156:159], v[28:31]
    v_mfma_f32_16x16x32_f16 v[32:35], v[104:107], v[160:163], v[32:35]
    v_mfma_f32_16x16x32_f16 v[36:39], v[104:107], v[164:167], v[36:39]
    v_mfma_f32_16x16x32_f16 v[40:43], v[104:107], v[168:171], 0
    s_waitcnt lgkmcnt(12)
    v_mfma_f32_16x16x32_f16 v[32:35], v[92:95], v[172:175], v[32:35]
    ds_read_b128 v[192:195], v70 offset:640
    v_mfma_f32_16x16x32_f16 v[36:39], v[96:99], v[172:175], v[36:39]
    ds_read2_b32 v[128:129], v66 offset0:96 offset1:97
    v_mfma_f32_16x16x32_f16 v[40:43], v[100:103], v[172:175], v[40:43]
    ds_read2_b32 v[130:131], v66 offset0:98 offset1:99
    v_mfma_f32_16x16x32_f16 v[44:47], v[104:107], v[172:175], 0
    v_mfma_f32_16x16x32_f16 v[32:35], v[108:111], v[156:159], v[32:35]
    v_mfma_f32_16x16x32_f16 v[36:39], v[108:111], v[160:163], v[36:39]
    v_mfma_f32_16x16x32_f16 v[40:43], v[108:111], v[164:167], v[40:43]
    v_mfma_f32_16x16x32_f16 v[44:47], v[108:111], v[168:171], v[44:47]
    s_waitcnt lgkmcnt(12)
    v_mfma_f32_16x16x32_f16 v[36:39], v[92:95], v[176:179], v[36:39]
    ds_read_b128 v[196:199], v70 offset:1152
    v_mfma_f32_16x16x32_f16 v[40:43], v[96:99], v[176:179], v[40:43]
    ds_read2_b32 v[132:133], v67 offset0:224 offset1:225
    v_mfma_f32_16x16x32_f16 v[44:47], v[100:103], v[176:179], v[44:47]
    ds_read2_b32 v[134:135], v67 offset0:226 offset1:227
    v_mfma_f32_16x16x32_f16 v[36:39], v[112:115], v[156:159], v[36:39]
    v_mfma_f32_16x16x32_f16 v[40:43], v[112:115], v[160:163], v[40:43]
    v_mfma_f32_16x16x32_f16 v[44:47], v[112:115], v[164:167], v[44:47]
    s_waitcnt lgkmcnt(12)
    v_mfma_f32_16x16x32_f16 v[40:43], v[92:95], v[180:183], v[40:43]
    ds_read_b128 v[200:203], v70 offset:1664
    v_mfma_f32_16x16x32_f16 v[44:47], v[96:99], v[180:183], v[44:47]
    ds_read2_b32 v[136:137], v67 offset0:96 offset1:97
    v_mfma_f32_16x16x32_f16 v[40:43], v[116:119], v[156:159], v[40:43]
    ds_read2_b32 v[138:139], v67 offset0:98 offset1:99
    v_mfma_f32_16x16x32_f16 v[44:47], v[116:119], v[160:163], v[44:47]
    s_waitcnt lgkmcnt(12)
    v_mfma_f32_16x16x32_f16 v[44:47], v[92:95], v[184:187], v[44:47]
    ds_read_b128 v[204:207], v70 offset:2176
    ds_read2_b32 v[140:141], v68 offset0:224 offset1:225
    v_mfma_f32_16x16x32_f16 v[44:47], v[120:123], v[156:159], v[44:47]
    ds_read2_b32 v[142:143], v68 offset0:226 offset1:227
    s_waitcnt lgkmcnt(12)
    v_mfma_f32_16x16x32_f16 v[16:19], v[124:127], v[188:191], v[16:19]
    ds_read_b128 v[208:211], v70 offset:2688
    ds_read2_b32 v[144:145], v68 offset0:96 offset1:97
    ds_read2_b32 v[146:147], v68 offset0:98 offset1:99
    s_waitcnt lgkmcnt(12)
    v_mfma_f32_16x16x32_f16 v[20:23], v[124:127], v[192:195], v[20:23]
    ds_read_b128 v[212:215], v70 offset:3200
    v_mfma_f32_16x16x32_f16 v[20:23], v[128:131], v[188:191], v[20:23]
    ds_read2_b32 v[148:149], v69 offset0:224 offset1:225
    v_mfma_f32_16x16x32_f16 v[24:27], v[128:131], v[192:195], v[24:27]
    ds_read2_b32 v[150:151], v69 offset0:226 offset1:227
    s_waitcnt lgkmcnt(12)
    v_mfma_f32_16x16x32_f16 v[24:27], v[124:127], v[196:199], v[24:27]
    ds_read_b128 v[216:219], v70 offset:3712
    v_mfma_f32_16x16x32_f16 v[28:31], v[128:131], v[196:199], v[28:31]
    ds_read2_b32 v[152:153], v69 offset0:96 offset1:97
    v_mfma_f32_16x16x32_f16 v[24:27], v[132:135], v[188:191], v[24:27]
    ds_read2_b32 v[154:155], v69 offset0:98 offset1:99
    v_mfma_f32_16x16x32_f16 v[28:31], v[132:135], v[192:195], v[28:31]
    v_mfma_f32_16x16x32_f16 v[32:35], v[132:135], v[196:199], v[32:35]
    s_waitcnt lgkmcnt(12)
    v_mfma_f32_16x16x32_f16 v[28:31], v[124:127], v[200:203], v[28:31]
    ds_read_b128 v[156:159], v70 offset:64
    v_mfma_f32_16x16x32_f16 v[32:35], v[128:131], v[200:203], v[32:35]
    ds_read2_b32 v[92:93], v66 offset0:208 offset1:209
    v_mfma_f32_16x16x32_f16 v[36:39], v[132:135], v[200:203], v[36:39]
    ds_read2_b32 v[94:95], v66 offset0:210 offset1:211
    v_mfma_f32_16x16x32_f16 v[28:31], v[136:139], v[188:191], v[28:31]
    v_mfma_f32_16x16x32_f16 v[32:35], v[136:139], v[192:195], v[32:35]
    v_mfma_f32_16x16x32_f16 v[36:39], v[136:139], v[196:199], v[36:39]
    v_mfma_f32_16x16x32_f16 v[40:43], v[136:139], v[200:203], v[40:43]
    s_waitcnt lgkmcnt(12)
    v_mfma_f32_16x16x32_f16 v[32:35], v[124:127], v[204:207], v[32:35]
    ds_read_b128 v[160:163], v70 offset:576
    v_mfma_f32_16x16x32_f16 v[36:39], v[128:131], v[204:207], v[36:39]
    ds_read2_b32 v[96:97], v66 offset0:80 offset1:81
    v_mfma_f32_16x16x32_f16 v[40:43], v[132:135], v[204:207], v[40:43]
    ds_read2_b32 v[98:99], v66 offset0:82 offset1:83
    v_mfma_f32_16x16x32_f16 v[44:47], v[136:139], v[204:207], v[44:47]
    v_mfma_f32_16x16x32_f16 v[32:35], v[140:143], v[188:191], v[32:35]
    v_mfma_f32_16x16x32_f16 v[36:39], v[140:143], v[192:195], v[36:39]
    v_mfma_f32_16x16x32_f16 v[40:43], v[140:143], v[196:199], v[40:43]
    v_mfma_f32_16x16x32_f16 v[44:47], v[140:143], v[200:203], v[44:47]
    s_waitcnt lgkmcnt(12)
    v_mfma_f32_16x16x32_f16 v[36:39], v[124:127], v[208:211], v[36:39]
    ds_read_b128 v[164:167], v70 offset:1088
    v_mfma_f32_16x16x32_f16 v[40:43], v[128:131], v[208:211], v[40:43]
    ds_read2_b32 v[100:101], v67 offset0:208 offset1:209
    v_mfma_f32_16x16x32_f16 v[44:47], v[132:135], v[208:211], v[44:47]
    ds_read2_b32 v[102:103], v67 offset0:210 offset1:211
    v_mfma_f32_16x16x32_f16 v[36:39], v[144:147], v[188:191], v[36:39]
    v_mfma_f32_16x16x32_f16 v[40:43], v[144:147], v[192:195], v[40:43]
    v_mfma_f32_16x16x32_f16 v[44:47], v[144:147], v[196:199], v[44:47]
    s_waitcnt lgkmcnt(12)
    v_mfma_f32_16x16x32_f16 v[40:43], v[124:127], v[212:215], v[40:43]
    ds_read_b128 v[168:171], v70 offset:1600
    v_mfma_f32_16x16x32_f16 v[44:47], v[128:131], v[212:215], v[44:47]
    ds_read2_b32 v[104:105], v67 offset0:80 offset1:81
    v_mfma_f32_16x16x32_f16 v[40:43], v[148:151], v[188:191], v[40:43]
    ds_read2_b32 v[106:107], v67 offset0:82 offset1:83
    v_mfma_f32_16x16x32_f16 v[44:47], v[148:151], v[192:195], v[44:47]
    s_waitcnt lgkmcnt(12)
    v_mfma_f32_16x16x32_f16 v[44:47], v[124:127], v[216:219], v[44:47]
    ds_read_b128 v[172:175], v70 offset:2112
    ds_read2_b32 v[108:109], v68 offset0:208 offset1:209
    v_mfma_f32_16x16x32_f16 v[44:47], v[152:155], v[188:191], v[44:47]
    ds_read2_b32 v[110:111], v68 offset0:210 offset1:211
    s_waitcnt lgkmcnt(12)
    v_mfma_f32_16x16x32_f16 v[16:19], v[92:95], v[156:159], v[16:19]
    ds_read_b128 v[176:179], v70 offset:2624
    ds_read2_b32 v[112:113], v68 offset0:80 offset1:81
    ds_read2_b32 v[114:115], v68 offset0:82 offset1:83
    s_waitcnt lgkmcnt(12)
    v_mfma_f32_16x16x32_f16 v[20:23], v[92:95], v[160:163], v[20:23]
    ds_read_b128 v[180:183], v70 offset:3136
    v_mfma_f32_16x16x32_f16 v[20:23], v[96:99], v[156:159], v[20:23]
    ds_read2_b32 v[116:117], v69 offset0:208 offset1:209
    v_mfma_f32_16x16x32_f16 v[24:27], v[96:99], v[160:163], v[24:27]
    ds_read2_b32 v[118:119], v69 offset0:210 offset1:211
    s_waitcnt lgkmcnt(12)
    v_mfma_f32_16x16x32_f16 v[24:27], v[92:95], v[164:167], v[24:27]
    ds_read_b128 v[184:187], v70 offset:3648
    v_mfma_f32_16x16x32_f16 v[28:31], v[96:99], v[164:167], v[28:31]
    ds_read2_b32 v[120:121], v69 offset0:80 offset1:81
    v_mfma_f32_16x16x32_f16 v[24:27], v[100:103], v[156:159], v[24:27]
    ds_read2_b32 v[122:123], v69 offset0:82 offset1:83
    v_mfma_f32_16x16x32_f16 v[28:31], v[100:103], v[160:163], v[28:31]
    v_mfma_f32_16x16x32_f16 v[32:35], v[100:103], v[164:167], v[32:35]
    s_waitcnt lgkmcnt(12)
    v_mfma_f32_16x16x32_f16 v[28:31], v[92:95], v[168:171], v[28:31]
    ds_read_b128 v[188:191], v70 offset:0
    v_mfma_f32_16x16x32_f16 v[32:35], v[96:99], v[168:171], v[32:35]
    ds_read2_b32 v[124:125], v66 offset0:192 offset1:193
    v_mfma_f32_16x16x32_f16 v[36:39], v[100:103], v[168:171], v[36:39]
    ds_read2_b32 v[126:127], v66 offset0:194 offset1:195
    v_mfma_f32_16x16x32_f16 v[28:31], v[104:107], v[156:159], v[28:31]
    v_mfma_f32_16x16x32_f16 v[32:35], v[104:107], v[160:163], v[32:35]
    v_mfma_f32_16x16x32_f16 v[36:39], v[104:107], v[164:167], v[36:39]
    v_mfma_f32_16x16x32_f16 v[40:43], v[104:107], v[168:171], v[40:43]
    s_waitcnt lgkmcnt(12)
    v_mfma_f32_16x16x32_f16 v[32:35], v[92:95], v[172:175], v[32:35]
    ds_read_b128 v[192:195], v70 offset:512
    v_mfma_f32_16x16x32_f16 v[36:39], v[96:99], v[172:175], v[36:39]
    ds_read2_b32 v[128:129], v66 offset0:64 offset1:65
    v_mfma_f32_16x16x32_f16 v[40:43], v[100:103], v[172:175], v[40:43]
    ds_read2_b32 v[130:131], v66 offset0:66 offset1:67
    v_mfma_f32_16x16x32_f16 v[44:47], v[104:107], v[172:175], v[44:47]
    v_mfma_f32_16x16x32_f16 v[32:35], v[108:111], v[156:159], v[32:35]
    v_mfma_f32_16x16x32_f16 v[36:39], v[108:111], v[160:163], v[36:39]
    v_mfma_f32_16x16x32_f16 v[40:43], v[108:111], v[164:167], v[40:43]
    v_mfma_f32_16x16x32_f16 v[44:47], v[108:111], v[168:171], v[44:47]
    s_waitcnt lgkmcnt(12)
    v_mfma_f32_16x16x32_f16 v[36:39], v[92:95], v[176:179], v[36:39]
    ds_read_b128 v[196:199], v70 offset:1024
    v_mfma_f32_16x16x32_f16 v[40:43], v[96:99], v[176:179], v[40:43]
    ds_read2_b32 v[132:133], v67 offset0:192 offset1:193
    v_mfma_f32_16x16x32_f16 v[44:47], v[100:103], v[176:179], v[44:47]
    ds_read2_b32 v[134:135], v67 offset0:194 offset1:195
    v_mfma_f32_16x16x32_f16 v[36:39], v[112:115], v[156:159], v[36:39]
    v_mfma_f32_16x16x32_f16 v[40:43], v[112:115], v[160:163], v[40:43]
    v_mfma_f32_16x16x32_f16 v[44:47], v[112:115], v[164:167], v[44:47]
    s_waitcnt lgkmcnt(12)
    v_mfma_f32_16x16x32_f16 v[40:43], v[92:95], v[180:183], v[40:43]
    ds_read_b128 v[200:203], v70 offset:1536
    v_mfma_f32_16x16x32_f16 v[44:47], v[96:99], v[180:183], v[44:47]
    ds_read2_b32 v[136:137], v67 offset0:64 offset1:65
    v_mfma_f32_16x16x32_f16 v[40:43], v[116:119], v[156:159], v[40:43]
    ds_read2_b32 v[138:139], v67 offset0:66 offset1:67
    v_mfma_f32_16x16x32_f16 v[44:47], v[116:119], v[160:163], v[44:47]
    s_waitcnt lgkmcnt(12)
    v_mfma_f32_16x16x32_f16 v[44:47], v[92:95], v[184:187], v[44:47]
    ds_read_b128 v[204:207], v70 offset:2048
    ds_read2_b32 v[140:141], v68 offset0:192 offset1:193
    v_mfma_f32_16x16x32_f16 v[44:47], v[120:123], v[156:159], v[44:47]
    ds_read2_b32 v[142:143], v68 offset0:194 offset1:195
    s_waitcnt lgkmcnt(12)
    v_mfma_f32_16x16x32_f16 v[16:19], v[124:127], v[188:191], v[16:19]
    ds_read_b128 v[208:211], v70 offset:2560
    ds_read2_b32 v[144:145], v68 offset0:64 offset1:65
    ds_read2_b32 v[146:147], v68 offset0:66 offset1:67
    s_waitcnt lgkmcnt(12)
    v_mfma_f32_16x16x32_f16 v[20:23], v[124:127], v[192:195], v[20:23]
    ds_read_b128 v[212:215], v70 offset:3072
    v_mfma_f32_16x16x32_f16 v[20:23], v[128:131], v[188:191], v[20:23]
    ds_read2_b32 v[148:149], v69 offset0:192 offset1:193
    v_mfma_f32_16x16x32_f16 v[24:27], v[128:131], v[192:195], v[24:27]
    ds_read2_b32 v[150:151], v69 offset0:194 offset1:195
    s_waitcnt lgkmcnt(12)
    v_mfma_f32_16x16x32_f16 v[24:27], v[124:127], v[196:199], v[24:27]
    ds_read_b128 v[216:219], v70 offset:3584
    v_mfma_f32_16x16x32_f16 v[28:31], v[128:131], v[196:199], v[28:31]
    ds_read2_b32 v[152:153], v69 offset0:64 offset1:65
    v_mfma_f32_16x16x32_f16 v[24:27], v[132:135], v[188:191], v[24:27]
    ds_read2_b32 v[154:155], v69 offset0:66 offset1:67
    v_mfma_f32_16x16x32_f16 v[28:31], v[132:135], v[192:195], v[28:31]
    v_mfma_f32_16x16x32_f16 v[32:35], v[132:135], v[196:199], v[32:35]
    s_waitcnt lgkmcnt(12)
    v_mfma_f32_16x16x32_f16 v[28:31], v[124:127], v[200:203], v[28:31]
    ds_write_b128 v71, v[16:19] offset:0
    v_mfma_f32_16x16x32_f16 v[32:35], v[128:131], v[200:203], v[32:35]
    v_mfma_f32_16x16x32_f16 v[36:39], v[132:135], v[200:203], v[36:39]
    v_mfma_f32_16x16x32_f16 v[28:31], v[136:139], v[188:191], v[28:31]
    ds_write_b128 v71, v[20:23] offset:1152
    v_mfma_f32_16x16x32_f16 v[32:35], v[136:139], v[192:195], v[32:35]
    v_mfma_f32_16x16x32_f16 v[36:39], v[136:139], v[196:199], v[36:39]
    v_mfma_f32_16x16x32_f16 v[40:43], v[136:139], v[200:203], v[40:43]
    s_waitcnt lgkmcnt(11)
    v_mfma_f32_16x16x32_f16 v[32:35], v[124:127], v[204:207], v[32:35]
    v_mfma_f32_16x16x32_f16 v[36:39], v[128:131], v[204:207], v[36:39]
    ds_write_b128 v71, v[24:27] offset:2304
    v_mfma_f32_16x16x32_f16 v[40:43], v[132:135], v[204:207], v[40:43]
    v_mfma_f32_16x16x32_f16 v[44:47], v[136:139], v[204:207], v[44:47]
    v_mfma_f32_16x16x32_f16 v[32:35], v[140:143], v[188:191], v[32:35]
    v_mfma_f32_16x16x32_f16 v[36:39], v[140:143], v[192:195], v[36:39]
    v_mfma_f32_16x16x32_f16 v[40:43], v[140:143], v[196:199], v[40:43]
    v_mfma_f32_16x16x32_f16 v[44:47], v[140:143], v[200:203], v[44:47]
    s_waitcnt lgkmcnt(9)
    v_mfma_f32_16x16x32_f16 v[36:39], v[124:127], v[208:211], v[36:39]
    ds_write_b128 v71, v[28:31] offset:3456
    v_mfma_f32_16x16x32_f16 v[40:43], v[128:131], v[208:211], v[40:43]
    v_mfma_f32_16x16x32_f16 v[44:47], v[132:135], v[208:211], v[44:47]
    v_mfma_f32_16x16x32_f16 v[36:39], v[144:147], v[188:191], v[36:39]
    v_mfma_f32_16x16x32_f16 v[40:43], v[144:147], v[192:195], v[40:43]
    v_mfma_f32_16x16x32_f16 v[44:47], v[144:147], v[196:199], v[44:47]
    s_waitcnt lgkmcnt(7)
    v_mfma_f32_16x16x32_f16 v[40:43], v[124:127], v[212:215], v[40:43]
    v_mfma_f32_16x16x32_f16 v[44:47], v[128:131], v[212:215], v[44:47]
    v_mfma_f32_16x16x32_f16 v[40:43], v[148:151], v[188:191], v[40:43]
    ds_write_b128 v71, v[32:35] offset:4608
    v_mfma_f32_16x16x32_f16 v[44:47], v[148:151], v[192:195], v[44:47]
    s_waitcnt lgkmcnt(5)
    v_mfma_f32_16x16x32_f16 v[44:47], v[124:127], v[216:219], v[44:47]
    v_mfma_f32_16x16x32_f16 v[44:47], v[152:155], v[188:191], v[44:47]
    ds_write_b128 v71, v[36:39] offset:5760
    s_nop 1
    ds_write_b128 v71, v[40:43] offset:6912
    s_nop 3
    ds_write_b128 v71, v[44:47] offset:8064
    s_branch L_c_be
L_c_roleB:
    s_waitcnt vmcnt(0)
    v_mov_b32 v14, -1
    v_mov_b32 v15, -1
    v_mov_b32 v16, -1
    v_mov_b32 v17, -1
    v_add_u32 v18, 5238784, v13
    global_store_dwordx4 v18, v[14:17], s[36:37] sc1
    v_add_u32 v18, 4096, v18
    global_store_dwordx4 v18, v[14:17], s[36:37] sc1
    s_lshl_b32 s6, s3, 5
    s_add_u32 s6, s6, 262144
    v_lshl_add_u32 v18, v1, 2, s6
    s_mov_b64 exec, 0xff
    global_store_dword v18, v14, s[36:37] sc1
    s_mov_b64 exec, -1
L_c_be:
    s_waitcnt lgkmcnt(0)
    s_barrier
    ds_read_b128 v[16:19], v48
    ds_read_b128 v[24:27], v48 offset:18560
    ds_read_b128 v[20:23], v48 offset:256
    ds_read_b128 v[28:31], v48 offset:18816
    ds_read_b32 v14, v64 offset:30208
    s_waitcnt lgkmcnt(0)
    v_pk_add_f32 v[16:17], v[16:17], v[24:25]
    v_pk_add_f32 v[18:19], v[18:19], v[26:27]
    v_pk_add_f32 v[20:21], v[20:21], v[28:29]
    v_pk_add_f32 v[22:23], v[22:23], v[30:31]
    v_pk_mul_f32 v[16:17], v[16:17], v[14:15] op_sel_hi:[1,0]
    v_pk_mul_f32 v[18:19], v[18:19], v[14:15] op_sel_hi:[1,0]
    v_pk_mul_f32 v[20:21], v[20:21], v[14:15] op_sel_hi:[1,0]
    v_pk_mul_f32 v[22:23], v[22:23], v[14:15] op_sel_hi:[1,0]
    v_cvt_pk_bf16_f32 v24, v16, v17
    v_cvt_pk_bf16_f32 v25, v18, v19
    v_cvt_pk_bf16_f32 v26, v20, v21
    v_cvt_pk_bf16_f32 v27, v22, v23
    global_store_dwordx4 v65, v[24:27], s[36:37] sc1
    v_lshrrev_b32 v14, 1, v0
    v_lshlrev_b32 v14, 13, v14
    v_and_b32 v2, 1, v0
    v_lshl_add_u32 v14, v2, 4, v14
    s_lshl_b32 s6, s3, 5
    s_add_u32 s6, s6, 3145728
    v_add_u32 v14, s6, v14
    ds_read_b128 v[20:23], v10 offset:34048
    v_lshl_add_u32 v4, v1, 4, s42
    v_lshrrev_b32 v2, 4, v1
    v_lshlrev_b32 v5, 8, v2
    v_bfe_u32 v2, v1, 1, 1
    v_lshl_add_u32 v5, v2, 7, v5
    v_bfe_u32 v2, v1, 2, 2
    v_lshl_add_u32 v5, v2, 4, v5
    v_and_b32 v2, 1, v1
    v_lshl_add_u32 v5, v2, 3, v5
    v_add_u32 v5, s42, v5
    s_waitcnt vmcnt(0)
    s_mov_b32 s60, 0
L_y_8:
    global_load_dwordx4 v[16:19], v14, s[36:37] sc1
    s_waitcnt vmcnt(0)
    v_max_u32 v2, v16, v17
    v_max3_u32 v2, v2, v18, v19
    v_cmp_eq_u32 vcc, -1, v2
    s_nop 3
    s_cbranch_vccz L_yok_9
    s_mov_b64 exec, vcc
    s_add_u32 s60, s60, 1
    s_cmp_lt_u32 s60, 32768
    s_cbranch_scc1 L_y_8
L_yok_9:
    s_mov_b64 exec, -1
    ds_write_b128 v4, v[16:19]
    s_waitcnt lgkmcnt(0)
    ds_read_b64_tr_b16 v[16:17], v5
    ds_read_b64_tr_b16 v[18:19], v5 offset:64
    s_waitcnt lgkmcnt(0)
    v_lshlrev_b32 v24, 16, v16
    v_and_b32 v25, s67, v16
    v_lshlrev_b32 v26, 16, v17
    v_and_b32 v27, s67, v17
    v_lshlrev_b32 v28, 16, v18
    v_and_b32 v29, s67, v18
    v_lshlrev_b32 v30, 16, v19
    v_and_b32 v31, s67, v19
    v_pk_add_f32 v[24:25], v[24:25], v[80:81]
    v_pk_add_f32 v[26:27], v[26:27], v[82:83]
    v_pk_add_f32 v[28:29], v[28:29], v[84:85]
    v_pk_add_f32 v[30:31], v[30:31], v[86:87]
    v_cvt_pk_bf16_f32 v32, v24, v25
    v_cvt_pk_bf16_f32 v33, v26, v27
    v_cvt_pk_bf16_f32 v34, v28, v29
    v_cvt_pk_bf16_f32 v35, v30, v31
    v_lshlrev_b32 v24, 16, v32
    v_and_b32 v25, s67, v32
    v_lshlrev_b32 v26, 16, v33
    v_and_b32 v27, s67, v33
    v_lshlrev_b32 v28, 16, v34
    v_and_b32 v29, s67, v34
    v_lshlrev_b32 v30, 16, v35
    v_and_b32 v31, s67, v35
    v_pk_add_f32 v[24:25], v[24:25], v[72:73]
    v_pk_add_f32 v[26:27], v[26:27], v[74:75]
    v_pk_add_f32 v[28:29], v[28:29], v[76:77]
    v_pk_add_f32 v[30:31], v[30:31], v[78:79]
    v_cvt_pk_bf16_f32 v60, v24, v25
    v_cvt_pk_bf16_f32 v61, v26, v27
    v_cvt_pk_bf16_f32 v62, v28, v29
    v_cvt_pk_bf16_f32 v63, v30, v31
    v_dot2_f32_bf16 v40, v60, s68, 0
    v_dot2_f32_bf16 v41, v60, v60, 0
    v_dot2_f32_bf16 v40, v61, s68, v40
    v_dot2_f32_bf16 v41, v61, v61, v41
    v_dot2_f32_bf16 v40, v62, s68, v40
    v_dot2_f32_bf16 v41, v62, v62, v41
    v_dot2_f32_bf16 v40, v63, s68, v40
    v_dot2_f32_bf16 v41, v63, v63, v41
    s_lshl_b32 s6, s4, 3
    s_nop 0
    v_add_f32_dpp v40, v40, v40 row_ror:8 row_mask:0xf bank_mask:0xf
    v_add_f32_dpp v41, v41, v41 row_ror:8 row_mask:0xf bank_mask:0xf
    v_mov_b32 v42, v40
    v_mov_b32 v43, v41
    s_nop 0
    v_permlane16_swap_b32 v42, v40
    v_permlane16_swap_b32 v43, v41
    v_pk_add_f32 v[40:41], v[40:41], v[42:43]
    v_mov_b32 v42, v40
    v_mov_b32 v43, v41
    s_nop 0
    v_permlane32_swap_b32 v42, v40
    v_permlane32_swap_b32 v43, v41
    v_pk_add_f32 v[40:41], v[40:41], v[42:43]
    v_lshl_add_u32 v42, v8, 6, s6
    s_mov_b64 exec, 0xff
    ds_write_b64 v42, v[40:41] offset:29440
    s_mov_b64 exec, -1
    v_lshlrev_b32 v50, 16, v60
    v_and_b32 v51, s67, v60
    v_lshlrev_b32 v52, 16, v61
    v_and_b32 v53, s67, v61
    v_lshlrev_b32 v54, 16, v62
    v_and_b32 v55, s67, v62
    v_lshlrev_b32 v56, 16, v63
    v_and_b32 v57, s67, v63
    s_waitcnt lgkmcnt(0)
    s_barrier
    v_lshlrev_b32 v42, 6, v8
    ds_read_b128 v[24:27], v42 offset:29440
    ds_read_b128 v[28:31], v42 offset:29456
    ds_read_b128 v[32:35], v42 offset:29472
    ds_read_b128 v[36:39], v42 offset:29488
    s_waitcnt lgkmcnt(0)
    v_pk_add_f32 v[24:25], v[24:25], v[26:27]
    v_pk_add_f32 v[28:29], v[28:29], v[30:31]
    v_pk_add_f32 v[32:33], v[32:33], v[34:35]
    v_pk_add_f32 v[36:37], v[36:37], v[38:39]
    v_pk_add_f32 v[24:25], v[24:25], v[28:29]
    v_pk_add_f32 v[32:33], v[32:33], v[36:37]
    v_pk_add_f32 v[40:41], v[24:25], v[32:33]
    v_mul_f32 v40, 0x3b000000, v40
    v_mul_f32 v41, 0x3b000000, v41
    v_fma_f32 v41, -v40, v40, v41
    v_max_f32 v41, 0, v41
    v_cvt_pk_bf16_f32 v42, v40, v41
    v_lshlrev_b32 v48, 16, v42
    v_and_b32 v42, s67, v42
    v_add_f32 v42, s66, v42
    v_cvt_pk_bf16_f32 v42, v42, v42
    v_lshlrev_b32 v42, 16, v42
    v_sqrt_f32 v42, v42
    s_nop 0
    v_cvt_pk_bf16_f32 v42, v42, v42
    v_lshlrev_b32 v46, 16, v42
    v_rcp_f32 v44, v46
    v_pk_add_f32 v[24:25], v[50:51], v[48:49] op_sel_hi:[1,0] neg_lo:[0,1] neg_hi:[0,1]
    v_pk_add_f32 v[26:27], v[52:53], v[48:49] op_sel_hi:[1,0] neg_lo:[0,1] neg_hi:[0,1]
    v_pk_add_f32 v[28:29], v[54:55], v[48:49] op_sel_hi:[1,0] neg_lo:[0,1] neg_hi:[0,1]
    v_pk_add_f32 v[30:31], v[56:57], v[48:49] op_sel_hi:[1,0] neg_lo:[0,1] neg_hi:[0,1]
    v_cvt_pk_bf16_f32 v32, v24, v25
    v_cvt_pk_bf16_f32 v33, v26, v27
    v_cvt_pk_bf16_f32 v34, v28, v29
    v_cvt_pk_bf16_f32 v35, v30, v31
    v_lshlrev_b32 v24, 16, v32
    v_and_b32 v25, s67, v32
    v_lshlrev_b32 v26, 16, v33
    v_and_b32 v27, s67, v33
    v_lshlrev_b32 v28, 16, v34
    v_and_b32 v29, s67, v34
    v_lshlrev_b32 v30, 16, v35
    v_and_b32 v31, s67, v35
    v_pk_mul_f32 v[24:25], v[24:25], v[44:45] op_sel_hi:[1,0]
    v_pk_mul_f32 v[26:27], v[26:27], v[44:45] op_sel_hi:[1,0]
    v_pk_mul_f32 v[28:29], v[28:29], v[44:45] op_sel_hi:[1,0]
    v_pk_mul_f32 v[30:31], v[30:31], v[44:45] op_sel_hi:[1,0]
    v_cvt_pk_bf16_f32 v32, v24, v25
    v_cvt_pk_bf16_f32 v33, v26, v27
    v_cvt_pk_bf16_f32 v34, v28, v29
    v_cvt_pk_bf16_f32 v35, v30, v31
    v_dot2_f32_bf16 v58, v32, v20, 0
    v_dot2_f32_bf16 v59, v33, v21, 0
    v_dot2_f32_bf16 v58, v34, v22, v58
    v_dot2_f32_bf16 v59, v35, v23, v59
    s_nop 2
    v_add_f32 v58, v58, v59
    s_nop 1
    v_add_f32_dpp v58, v58, v58 row_ror:8 row_mask:0xf bank_mask:0xf
    v_mov_b32 v42, v58
    s_nop 1
    v_permlane16_swap_b32 v42, v58
    v_add_f32 v58, v58, v42
    v_mov_b32 v42, v58
    s_nop 1
    v_permlane32_swap_b32 v42, v58
    v_add_f32 v58, v58, v42
    s_lshl_b32 s6, s4, 2
    v_lshl_add_u32 v42, v8, 5, s6
    s_mov_b64 exec, 0xff
    ds_write_b32 v42, v58 offset:29952
    s_mov_b64 exec, -1
    v_lshlrev_b32 v24, 16, v32
    v_and_b32 v25, s67, v32
    v_lshlrev_b32 v26, 16, v33
    v_and_b32 v27, s67, v33
    v_lshlrev_b32 v28, 16, v34
    v_and_b32 v29, s67, v34
    v_lshlrev_b32 v30, 16, v35
    v_and_b32 v31, s67, v35
    v_pk_add_f32 v[24:25], v[24:25], v[50:51]
    v_pk_add_f32 v[26:27], v[26:27], v[52:53]
    v_pk_add_f32 v[28:29], v[28:29], v[54:55]
    v_pk_add_f32 v[30:31], v[30:31], v[56:57]
    v_cvt_pk_bf16_f32 v36, v24, v25
    v_cvt_pk_bf16_f32 v37, v26, v27
    v_cvt_pk_bf16_f32 v38, v28, v29
    v_cvt_pk_bf16_f32 v39, v30, v31
    s_waitcnt lgkmcnt(0)
    s_barrier
    s_cmp_eq_u32 s4, 0
    s_cbranch_scc0 L_s3_nokey
    v_lshlrev_b32 v42, 5, v8
    ds_read_b128 v[24:27], v42 offset:29952
    ds_read_b128 v[28:31], v42 offset:29968
    s_waitcnt lgkmcnt(0)
    v_pk_add_f32 v[24:25], v[24:25], v[26:27]
    v_pk_add_f32 v[28:29], v[28:29], v[30:31]
    v_pk_add_f32 v[24:25], v[24:25], v[28:29]
    v_add_f32 v24, v24, v25
    v_cvt_pk_bf16_f32 v24, v24, v24
    v_and_b32 v24, 0xffff, v24
    v_cmp_lt_u32 vcc, 0x7fff, v24
    v_xor_b32 v25, 0xffff, v24
    v_or_b32 v26, 0x8000, v24
    v_cndmask_b32 v24, v26, v25, vcc
    s_nop 1
    v_mov_b32_dpp v25, v24 quad_perm:[1,0,3,2] row_mask:0xf bank_mask:0xf
    s_lshl_b32 s6, s3, 4
    s_add_u32 s6, s6, 65536
    v_lshlrev_b32 v26, 12, v9
    v_lshl_add_u32 v26, v8, 1, v26
    v_add_u32 v26, s6, v26
    v_lshl_or_b32 v24, v25, 16, v24
    s_mov_b32 exec_lo, 0x55555555
    s_mov_b32 exec_hi, 0x55555555
    global_store_dword v26, v24, s[36:37] sc1
    s_mov_b64 exec, -1
L_s3_nokey:
    v_add_u32 v2, 5242880, v12
    global_store_dwordx4 v2, v[60:63], s[36:37] sc1
    v_mov_b32 v64, v36
    v_mov_b32 v65, v37
    v_mov_b32 v66, v38
    v_mov_b32 v67, v39
    s_cmp_eq_u32 s4, 1
    s_cbranch_scc0 L_s3_nostat
    v_lshrrev_b32 v24, 16, v48
    v_and_or_b32 v24, v46, s67, v24
    s_lshl_b32 s6, s3, 5
    s_add_u32 s6, s6, 262144
    v_lshl_add_u32 v25, v8, 2, s6
    s_mov_b64 exec, 0xff
    global_store_dword v25, v24, s[36:37] sc1
    s_mov_b64 exec, -1
L_s3_nostat:
    s_mov_b32 s43, 1
    s_cmp_lt_u32 s2, 56
    s_cbranch_scc1 L_f_go
    s_mov_b32 s43, 2
    s_sub_u32 s7, s2, 64
    s_cmp_lt_u32 s7, 32
    s_cbranch_scc1 L_f_go
    s_mov_b32 s43, 0
    s_branch L_f_nokey
L_f_go:
L_f_nokey:
    s_cmp_eq_u32 s43, 0
    s_cbranch_scc0 L_f_roles
    s_waitcnt vmcnt(0)
    global_store_dwordx4 v12, v[64:67], s[32:33] sc1
    s_waitcnt vmcnt(0)
    s_barrier
    s_cmp_eq_u32 s4, 2
    s_cbranch_scc0 L_f3b_10
    s_lshl_b32 s6, s3, 4
    s_add_u32 s6, s6, 360448
    v_lshl_add_u32 v2, v1, 12, s6
    v_mov_b32 v3, s5
    s_mov_b64 exec, 0xff
    global_store_dword v2, v3, s[36:37] sc1
    s_mov_b64 exec, -1
L_f3b_10:
    s_branch L_fin
L_f_roles:
    s_cmp_ge_u32 s4, 4
    s_cbranch_scc1 L_t_roleB
    s_and_b32 s6, s2, 7
    s_lshl_b32 s6, s6, 12
    s_add_u32 s6, s6, 65536
    v_lshl_add_u32 v14, v0, 4, s6
    v_lshlrev_b32 v15, 3, v0
    v_sub_u32 v15, 2047, v15
    s_cmp_eq_u32 s4, 0
    s_cbranch_scc0 L_t_nz
    v_mov_b32 v2, 0
    v_lshlrev_b32 v3, 2, v1
    ds_write_b32 v3, v2 offset:30464
    v_mov_b32 v3, 30336
    ds_write_b32 v3, v2
L_t_nz:
    s_waitcnt vmcnt(0)
    s_mov_b32 s60, 0
L_key_11:
    global_load_dwordx4 v[28:31], v14, s[36:37] sc1
    s_waitcnt vmcnt(0)
    v_max_u32 v24, v28, v29
    v_max3_u32 v24, v24, v30, v31
    v_cmp_eq_u32 vcc, -1, v24
    s_nop 3
    s_cbranch_vccz L_keyok_12
    s_mov_b64 exec, vcc
    s_add_u32 s60, s60, 1
    s_cmp_lt_u32 s60, 32768
    s_cbranch_scc1 L_key_11
L_keyok_12:
    s_mov_b64 exec, -1
    v_subrev_u32 v2, 0, v15
    v_subrev_u32 v3, 1, v15
    v_lshl_or_b32 v16, v28, 16, v2
    v_and_or_b32 v17, v28, s67, v3
    v_subrev_u32 v2, 2, v15
    v_subrev_u32 v3, 3, v15
    v_lshl_or_b32 v18, v29, 16, v2
    v_and_or_b32 v19, v29, s67, v3
    v_subrev_u32 v2, 4, v15
    v_subrev_u32 v3, 5, v15
    v_lshl_or_b32 v20, v30, 16, v2
    v_and_or_b32 v21, v30, s67, v3
    v_subrev_u32 v2, 6, v15
    v_subrev_u32 v3, 7, v15
    v_lshl_or_b32 v22, v31, 16, v2
    v_and_or_b32 v23, v31, s67, v3
    v_max3_u32 v24, v16, v17, v18
    v_max3_u32 v25, v19, v20, v21
    v_max3_u32 v24, v24, v22, v23
    v_max_u32 v24, v24, v25
    global_store_dwordx4 v12, v[64:67], s[32:33] sc1
    s_nop 0
    v_max_u32_dpp v24, v24, v24 row_ror:1 row_mask:0xf bank_mask:0xf
    s_nop 1
    v_max_u32_dpp v24, v24, v24 row_ror:2 row_mask:0xf bank_mask:0xf
    s_nop 1
    v_max_u32_dpp v24, v24, v24 row_ror:4 row_mask:0xf bank_mask:0xf
    s_nop 1
    v_max_u32_dpp v24, v24, v24 row_ror:8 row_mask:0xf bank_mask:0xf
    s_lshl_b32 s6, s4, 4
    s_add_u32 s6, s6, 30272
    v_lshrrev_b32 v2, 4, v1
    v_lshl_add_u32 v2, v2, 2, s6
    s_mov_b32 exec_lo, 0x00010001
    s_mov_b32 exec_hi, 0x00010001
    ds_write_b32 v2, v24
    s_mov_b64 exec, -1
    v_mov_b32 v2, 30272
    v_mov_b32 v4, 30336
    v_and_b32 v3, 15, v1
    v_lshlrev_b32 v3, 2, v3
    v_mov_b32 v26, 0
    s_waitcnt lgkmcnt(0)
    s_barrier
    ds_read_b32 v15, v3 offset:30272
    ds_read_b128 v[28:31], v2 offset:0
    ds_read_b128 v[32:35], v2 offset:16
    ds_read_b128 v[36:39], v2 offset:32
    ds_read_b128 v[40:43], v2 offset:48
    s_waitcnt lgkmcnt(3)
    v_cmp_gt_u32 s[44:45], v28, v15
    v_cmp_gt_u32 s[46:47], v29, v15
    v_cmp_gt_u32 s[48:49], v30, v15
    v_cmp_gt_u32 s[50:51], v31, v15
    v_addc_co_u32 v26, vcc, 0, v26, s[44:45]
    v_addc_co_u32 v26, vcc, 0, v26, s[46:47]
    v_addc_co_u32 v26, vcc, 0, v26, s[48:49]
    v_addc_co_u32 v26, vcc, 0, v26, s[50:51]
    s_waitcnt lgkmcnt(2)
    v_cmp_gt_u32 s[44:45], v32, v15
    v_cmp_gt_u32 s[46:47], v33, v15
    v_cmp_gt_u32 s[48:49], v34, v15
    v_cmp_gt_u32 s[50:51], v35, v15
    v_addc_co_u32 v26, vcc, 0, v26, s[44:45]
    v_addc_co_u32 v26, vcc, 0, v26, s[46:47]
    v_addc_co_u32 v26, vcc, 0, v26, s[48:49]
    v_addc_co_u32 v26, vcc, 0, v26, s[50:51]
    s_waitcnt lgkmcnt(1)
    v_cmp_gt_u32 s[44:45], v36, v15
    v_cmp_gt_u32 s[46:47], v37, v15
    v_cmp_gt_u32 s[48:49], v38, v15
    v_cmp_gt_u32 s[50:51], v39, v15
    v_addc_co_u32 v26, vcc, 0, v26, s[44:45]
    v_addc_co_u32 v26, vcc, 0, v26, s[46:47]
    v_addc_co_u32 v26, vcc, 0, v26, s[48:49]
    v_addc_co_u32 v26, vcc, 0, v26, s[50:51]
    s_waitcnt lgkmcnt(0)
    v_cmp_gt_u32 s[44:45], v40, v15
    v_cmp_gt_u32 s[46:47], v41, v15
    v_cmp_gt_u32 s[48:49], v42, v15
    v_cmp_gt_u32 s[50:51], v43, v15
    v_addc_co_u32 v26, vcc, 0, v26, s[44:45]
    v_addc_co_u32 v26, vcc, 0, v26, s[46:47]
    v_addc_co_u32 v26, vcc, 0, v26, s[48:49]
    v_addc_co_u32 v26, vcc, 0, v26, s[50:51]
    v_cmp_eq_u32 vcc, 7, v26
    s_nop 3
    s_ff1_i32_b64 s6, vcc
    v_readlane_b32 s7, v15, s6
    s_nop 1
    v_mov_b32 v28, s7
    v_cmp_ge_u32 s[44:45], v16, v28
    v_cmp_ge_u32 s[46:47], v17, v28
    v_cmp_ge_u32 s[48:49], v18, v28
    v_cmp_ge_u32 s[50:51], v19, v28
    v_cmp_ge_u32 s[52:53], v20, v28
    v_cmp_ge_u32 s[54:55], v21, v28
    v_cmp_ge_u32 s[56:57], v22, v28
    v_cmp_ge_u32 s[58:59], v23, v28
    s_bcnt1_i32_b64 s7, s[44:45]
    s_bcnt1_i32_b64 s6, s[46:47]
    s_add_u32 s7, s7, s6
    s_bcnt1_i32_b64 s6, s[48:49]
    s_add_u32 s7, s7, s6
    s_bcnt1_i32_b64 s6, s[50:51]
    s_add_u32 s7, s7, s6
    s_bcnt1_i32_b64 s6, s[52:53]
    s_add_u32 s7, s7, s6
    s_bcnt1_i32_b64 s6, s[54:55]
    s_add_u32 s7, s7, s6
    s_bcnt1_i32_b64 s6, s[56:57]
    s_add_u32 s7, s7, s6
    s_bcnt1_i32_b64 s6, s[58:59]
    s_add_u32 s7, s7, s6
    v_mov_b32 v3, s7
    s_mov_b64 exec, 1
    ds_add_rtn_u32 v5, v4, v3
    s_mov_b64 exec, -1
    s_mov_b32 s7, 0
    v_mbcnt_lo_u32_b32 v44, s44, 0
    v_mbcnt_hi_u32_b32 v44, s45, v44
    s_bcnt1_i32_b64 s6, s[44:45]
    s_add_u32 s7, s7, s6
    v_mbcnt_lo_u32_b32 v45, s46, 0
    v_mbcnt_hi_u32_b32 v45, s47, v45
    v_add_u32 v45, s7, v45
    s_bcnt1_i32_b64 s6, s[46:47]
    s_add_u32 s7, s7, s6
    v_mbcnt_lo_u32_b32 v46, s48, 0
    v_mbcnt_hi_u32_b32 v46, s49, v46
    v_add_u32 v46, s7, v46
    s_bcnt1_i32_b64 s6, s[48:49]
    s_add_u32 s7, s7, s6
    v_mbcnt_lo_u32_b32 v47, s50, 0
    v_mbcnt_hi_u32_b32 v47, s51, v47
    v_add_u32 v47, s7, v47
    s_bcnt1_i32_b64 s6, s[50:51]
    s_add_u32 s7, s7, s6
    v_mbcnt_lo_u32_b32 v48, s52, 0
    v_mbcnt_hi_u32_b32 v48, s53, v48
    v_add_u32 v48, s7, v48
    s_bcnt1_i32_b64 s6, s[52:53]
    s_add_u32 s7, s7, s6
    v_mbcnt_lo_u32_b32 v49, s54, 0
    v_mbcnt_hi_u32_b32 v49, s55, v49
    v_add_u32 v49, s7, v49
    s_bcnt1_i32_b64 s6, s[54:55]
    s_add_u32 s7, s7, s6
    v_mbcnt_lo_u32_b32 v50, s56, 0
    v_mbcnt_hi_u32_b32 v50, s57, v50
    v_add_u32 v50, s7, v50
    s_bcnt1_i32_b64 s6, s[56:57]
    s_add_u32 s7, s7, s6
    v_mbcnt_lo_u32_b32 v51, s58, 0
    v_mbcnt_hi_u32_b32 v51, s59, v51
    v_add_u32 v51, s7, v51
    s_waitcnt lgkmcnt(0)
    v_readfirstlane_b32 s7, v5
    s_nop 1
    v_add_u32 v44, s7, v44
    v_min_u32 v44, 64, v44
    v_lshlrev_b32 v44, 2, v44
    v_add_u32 v45, s7, v45
    v_min_u32 v45, 64, v45
    v_lshlrev_b32 v45, 2, v45
    v_add_u32 v46, s7, v46
    v_min_u32 v46, 64, v46
    v_lshlrev_b32 v46, 2, v46
    v_add_u32 v47, s7, v47
    v_min_u32 v47, 64, v47
    v_lshlrev_b32 v47, 2, v47
    v_add_u32 v48, s7, v48
    v_min_u32 v48, 64, v48
    v_lshlrev_b32 v48, 2, v48
    v_add_u32 v49, s7, v49
    v_min_u32 v49, 64, v49
    v_lshlrev_b32 v49, 2, v49
    v_add_u32 v50, s7, v50
    v_min_u32 v50, 64, v50
    v_lshlrev_b32 v50, 2, v50
    v_add_u32 v51, s7, v51
    v_min_u32 v51, 64, v51
    v_lshlrev_b32 v51, 2, v51
    s_mov_b64 exec, s[44:45]
    ds_write_b32 v44, v16 offset:30464
    s_mov_b64 exec, s[46:47]
    ds_write_b32 v45, v17 offset:30464
    s_mov_b64 exec, s[48:49]
    ds_write_b32 v46, v18 offset:30464
    s_mov_b64 exec, s[50:51]
    ds_write_b32 v47, v19 offset:30464
    s_mov_b64 exec, s[52:53]
    ds_write_b32 v48, v20 offset:30464
    s_mov_b64 exec, s[54:55]
    ds_write_b32 v49, v21 offset:30464
    s_mov_b64 exec, s[56:57]
    ds_write_b32 v50, v22 offset:30464
    s_mov_b64 exec, s[58:59]
    ds_write_b32 v51, v23 offset:30464
    s_mov_b64 exec, -1
    v_lshlrev_b32 v4, 2, v1
    v_mov_b32 v2, 30464
    v_mov_b32 v52, 0
    v_mov_b32 v5, 30336
    s_waitcnt lgkmcnt(0)
    s_barrier
    s_cmp_eq_u32 s4, 0
    s_cbranch_scc0 L_t_norank
    v_and_b32 v4, 15, v1
    v_lshlrev_b32 v4, 2, v4
    v_lshrrev_b32 v28, 4, v1
    v_lshlrev_b32 v28, 4, v28
    ds_read_b32 v3, v5
    ds_read_b32 v27, v4 offset:30464
    ds_read_b128 v[68:71], v28 offset:30464
    s_waitcnt lgkmcnt(0)
    v_readfirstlane_b32 s44, v3
    v_cmp_gt_u32 s[46:47], v68, v27
    v_cmp_gt_u32 s[48:49], v69, v27
    v_cmp_gt_u32 s[50:51], v70, v27
    v_cmp_gt_u32 s[52:53], v71, v27
    v_addc_co_u32 v52, vcc, 0, v52, s[46:47]
    v_addc_co_u32 v52, vcc, 0, v52, s[48:49]
    v_addc_co_u32 v52, vcc, 0, v52, s[50:51]
    v_addc_co_u32 v52, vcc, 0, v52, s[52:53]
    v_mov_b32 v3, v52
    s_nop 1
    v_permlane16_swap_b32 v3, v52
    v_add_u32 v52, v52, v3
    v_mov_b32 v3, v52
    s_nop 1
    v_permlane32_swap_b32 v3, v52
    v_add_u32 v52, v52, v3
    s_cmp_le_u32 s44, 16
    s_cbranch_scc0 L_t_n32
    s_mov_b64 exec, 0xffff
    v_lshlrev_b32 v2, 2, v52
    v_cmp_gt_u32 vcc, 8, v52
    s_nop 3
    s_and_b64 exec, exec, vcc
    ds_write_b32 v2, v27 offset:30976
    s_mov_b64 exec, -1
    s_branch L_t_norank
L_t_n32:
    v_mov_b32 v52, 0
    v_and_b32 v4, 31, v1
    v_lshlrev_b32 v4, 2, v4
    v_lshrrev_b32 v28, 5, v1
    v_lshlrev_b32 v28, 6, v28
    ds_read_b32 v3, v5
    ds_read_b32 v27, v4 offset:30464
    ds_read_b128 v[68:71], v28 offset:30464
    ds_read_b128 v[72:75], v28 offset:30480
    ds_read_b128 v[76:79], v28 offset:30496
    ds_read_b128 v[80:83], v28 offset:30512
    s_waitcnt lgkmcnt(0)
    v_readfirstlane_b32 s44, v3
    v_cmp_gt_u32 s[46:47], v68, v27
    v_cmp_gt_u32 s[48:49], v69, v27
    v_cmp_gt_u32 s[50:51], v70, v27
    v_cmp_gt_u32 s[52:53], v71, v27
    v_addc_co_u32 v52, vcc, 0, v52, s[46:47]
    v_addc_co_u32 v52, vcc, 0, v52, s[48:49]
    v_addc_co_u32 v52, vcc, 0, v52, s[50:51]
    v_addc_co_u32 v52, vcc, 0, v52, s[52:53]
    v_cmp_gt_u32 s[46:47], v72, v27
    v_cmp_gt_u32 s[48:49], v73, v27
    v_cmp_gt_u32 s[50:51], v74, v27
    v_cmp_gt_u32 s[52:53], v75, v27
    v_addc_co_u32 v52, vcc, 0, v52, s[46:47]
    v_addc_co_u32 v52, vcc, 0, v52, s[48:49]
    v_addc_co_u32 v52, vcc, 0, v52, s[50:51]
    v_addc_co_u32 v52, vcc, 0, v52, s[52:53]
    v_cmp_gt_u32 s[46:47], v76, v27
    v_cmp_gt_u32 s[48:49], v77, v27
    v_cmp_gt_u32 s[50:51], v78, v27
    v_cmp_gt_u32 s[52:53], v79, v27
    v_addc_co_u32 v52, vcc, 0, v52, s[46:47]
    v_addc_co_u32 v52, vcc, 0, v52, s[48:49]
    v_addc_co_u32 v52, vcc, 0, v52, s[50:51]
    v_addc_co_u32 v52, vcc, 0, v52, s[52:53]
    v_cmp_gt_u32 s[46:47], v80, v27
    v_cmp_gt_u32 s[48:49], v81, v27
    v_cmp_gt_u32 s[50:51], v82, v27
    v_cmp_gt_u32 s[52:53], v83, v27
    v_addc_co_u32 v52, vcc, 0, v52, s[46:47]
    v_addc_co_u32 v52, vcc, 0, v52, s[48:49]
    v_addc_co_u32 v52, vcc, 0, v52, s[50:51]
    v_addc_co_u32 v52, vcc, 0, v52, s[52:53]
    v_mov_b32 v3, v52
    s_nop 1
    v_permlane32_swap_b32 v3, v52
    v_add_u32 v52, v52, v3
    s_cmp_le_u32 s44, 32
    s_cbranch_scc0 L_t_slow
    s_mov_b32 exec_hi, 0
    v_lshlrev_b32 v2, 2, v52
    v_cmp_gt_u32 vcc, 8, v52
    s_nop 3
    s_and_b64 exec, exec, vcc
    ds_write_b32 v2, v27 offset:30976
    s_mov_b64 exec, -1
    s_branch L_t_norank
L_t_slow:
    s_cmp_gt_u32 s44, 64
    s_cbranch_scc1 L_f_fallback
    v_lshlrev_b32 v4, 2, v1
    v_mov_b32 v52, 0
    ds_read_b32 v27, v4 offset:30464
    ds_read_b128 v[68:71], v2 offset:0
    ds_read_b128 v[72:75], v2 offset:16
    ds_read_b128 v[76:79], v2 offset:32
    ds_read_b128 v[80:83], v2 offset:48
    ds_read_b128 v[84:87], v2 offset:64
    ds_read_b128 v[88:91], v2 offset:80
    ds_read_b128 v[92:95], v2 offset:96
    ds_read_b128 v[96:99], v2 offset:112
    ds_read_b128 v[100:103], v2 offset:128
    ds_read_b128 v[104:107], v2 offset:144
    ds_read_b128 v[108:111], v2 offset:160
    ds_read_b128 v[112:115], v2 offset:176
    ds_read_b128 v[116:119], v2 offset:192
    ds_read_b128 v[120:123], v2 offset:208
    ds_read_b128 v[124:127], v2 offset:224
    ds_read_b128 v[128:131], v2 offset:240
    s_waitcnt lgkmcnt(15)
    v_cmp_gt_u32 s[46:47], v68, v27
    v_cmp_gt_u32 s[48:49], v69, v27
    v_cmp_gt_u32 s[50:51], v70, v27
    v_cmp_gt_u32 s[52:53], v71, v27
    v_addc_co_u32 v52, vcc, 0, v52, s[46:47]
    v_addc_co_u32 v52, vcc, 0, v52, s[48:49]
    v_addc_co_u32 v52, vcc, 0, v52, s[50:51]
    v_addc_co_u32 v52, vcc, 0, v52, s[52:53]
    s_waitcnt lgkmcnt(14)
    v_cmp_gt_u32 s[46:47], v72, v27
    v_cmp_gt_u32 s[48:49], v73, v27
    v_cmp_gt_u32 s[50:51], v74, v27
    v_cmp_gt_u32 s[52:53], v75, v27
    v_addc_co_u32 v52, vcc, 0, v52, s[46:47]
    v_addc_co_u32 v52, vcc, 0, v52, s[48:49]
    v_addc_co_u32 v52, vcc, 0, v52, s[50:51]
    v_addc_co_u32 v52, vcc, 0, v52, s[52:53]
    s_waitcnt lgkmcnt(13)
    v_cmp_gt_u32 s[46:47], v76, v27
    v_cmp_gt_u32 s[48:49], v77, v27
    v_cmp_gt_u32 s[50:51], v78, v27
    v_cmp_gt_u32 s[52:53], v79, v27
    v_addc_co_u32 v52, vcc, 0, v52, s[46:47]
    v_addc_co_u32 v52, vcc, 0, v52, s[48:49]
    v_addc_co_u32 v52, vcc, 0, v52, s[50:51]
    v_addc_co_u32 v52, vcc, 0, v52, s[52:53]
    s_waitcnt lgkmcnt(12)
    v_cmp_gt_u32 s[46:47], v80, v27
    v_cmp_gt_u32 s[48:49], v81, v27
    v_cmp_gt_u32 s[50:51], v82, v27
    v_cmp_gt_u32 s[52:53], v83, v27
    v_addc_co_u32 v52, vcc, 0, v52, s[46:47]
    v_addc_co_u32 v52, vcc, 0, v52, s[48:49]
    v_addc_co_u32 v52, vcc, 0, v52, s[50:51]
    v_addc_co_u32 v52, vcc, 0, v52, s[52:53]
    s_waitcnt lgkmcnt(11)
    v_cmp_gt_u32 s[46:47], v84, v27
    v_cmp_gt_u32 s[48:49], v85, v27
    v_cmp_gt_u32 s[50:51], v86, v27
    v_cmp_gt_u32 s[52:53], v87, v27
    v_addc_co_u32 v52, vcc, 0, v52, s[46:47]
    v_addc_co_u32 v52, vcc, 0, v52, s[48:49]
    v_addc_co_u32 v52, vcc, 0, v52, s[50:51]
    v_addc_co_u32 v52, vcc, 0, v52, s[52:53]
    s_waitcnt lgkmcnt(10)
    v_cmp_gt_u32 s[46:47], v88, v27
    v_cmp_gt_u32 s[48:49], v89, v27
    v_cmp_gt_u32 s[50:51], v90, v27
    v_cmp_gt_u32 s[52:53], v91, v27
    v_addc_co_u32 v52, vcc, 0, v52, s[46:47]
    v_addc_co_u32 v52, vcc, 0, v52, s[48:49]
    v_addc_co_u32 v52, vcc, 0, v52, s[50:51]
    v_addc_co_u32 v52, vcc, 0, v52, s[52:53]
    s_waitcnt lgkmcnt(9)
    v_cmp_gt_u32 s[46:47], v92, v27
    v_cmp_gt_u32 s[48:49], v93, v27
    v_cmp_gt_u32 s[50:51], v94, v27
    v_cmp_gt_u32 s[52:53], v95, v27
    v_addc_co_u32 v52, vcc, 0, v52, s[46:47]
    v_addc_co_u32 v52, vcc, 0, v52, s[48:49]
    v_addc_co_u32 v52, vcc, 0, v52, s[50:51]
    v_addc_co_u32 v52, vcc, 0, v52, s[52:53]
    s_waitcnt lgkmcnt(8)
    v_cmp_gt_u32 s[46:47], v96, v27
    v_cmp_gt_u32 s[48:49], v97, v27
    v_cmp_gt_u32 s[50:51], v98, v27
    v_cmp_gt_u32 s[52:53], v99, v27
    v_addc_co_u32 v52, vcc, 0, v52, s[46:47]
    v_addc_co_u32 v52, vcc, 0, v52, s[48:49]
    v_addc_co_u32 v52, vcc, 0, v52, s[50:51]
    v_addc_co_u32 v52, vcc, 0, v52, s[52:53]
    s_cmp_le_u32 s44, 32
    s_cbranch_scc1 L_f_rankd
    s_waitcnt lgkmcnt(7)
    v_cmp_gt_u32 s[46:47], v100, v27
    v_cmp_gt_u32 s[48:49], v101, v27
    v_cmp_gt_u32 s[50:51], v102, v27
    v_cmp_gt_u32 s[52:53], v103, v27
    v_addc_co_u32 v52, vcc, 0, v52, s[46:47]
    v_addc_co_u32 v52, vcc, 0, v52, s[48:49]
    v_addc_co_u32 v52, vcc, 0, v52, s[50:51]
    v_addc_co_u32 v52, vcc, 0, v52, s[52:53]
    s_cmp_le_u32 s44, 36
    s_cbranch_scc1 L_f_rankd
    s_waitcnt lgkmcnt(6)
    v_cmp_gt_u32 s[46:47], v104, v27
    v_cmp_gt_u32 s[48:49], v105, v27
    v_cmp_gt_u32 s[50:51], v106, v27
    v_cmp_gt_u32 s[52:53], v107, v27
    v_addc_co_u32 v52, vcc, 0, v52, s[46:47]
    v_addc_co_u32 v52, vcc, 0, v52, s[48:49]
    v_addc_co_u32 v52, vcc, 0, v52, s[50:51]
    v_addc_co_u32 v52, vcc, 0, v52, s[52:53]
    s_cmp_le_u32 s44, 40
    s_cbranch_scc1 L_f_rankd
    s_waitcnt lgkmcnt(5)
    v_cmp_gt_u32 s[46:47], v108, v27
    v_cmp_gt_u32 s[48:49], v109, v27
    v_cmp_gt_u32 s[50:51], v110, v27
    v_cmp_gt_u32 s[52:53], v111, v27
    v_addc_co_u32 v52, vcc, 0, v52, s[46:47]
    v_addc_co_u32 v52, vcc, 0, v52, s[48:49]
    v_addc_co_u32 v52, vcc, 0, v52, s[50:51]
    v_addc_co_u32 v52, vcc, 0, v52, s[52:53]
    s_cmp_le_u32 s44, 44
    s_cbranch_scc1 L_f_rankd
    s_waitcnt lgkmcnt(4)
    v_cmp_gt_u32 s[46:47], v112, v27
    v_cmp_gt_u32 s[48:49], v113, v27
    v_cmp_gt_u32 s[50:51], v114, v27
    v_cmp_gt_u32 s[52:53], v115, v27
    v_addc_co_u32 v52, vcc, 0, v52, s[46:47]
    v_addc_co_u32 v52, vcc, 0, v52, s[48:49]
    v_addc_co_u32 v52, vcc, 0, v52, s[50:51]
    v_addc_co_u32 v52, vcc, 0, v52, s[52:53]
    s_cmp_le_u32 s44, 48
    s_cbranch_scc1 L_f_rankd
    s_waitcnt lgkmcnt(3)
    v_cmp_gt_u32 s[46:47], v116, v27
    v_cmp_gt_u32 s[48:49], v117, v27
    v_cmp_gt_u32 s[50:51], v118, v27
    v_cmp_gt_u32 s[52:53], v119, v27
    v_addc_co_u32 v52, vcc, 0, v52, s[46:47]
    v_addc_co_u32 v52, vcc, 0, v52, s[48:49]
    v_addc_co_u32 v52, vcc, 0, v52, s[50:51]
    v_addc_co_u32 v52, vcc, 0, v52, s[52:53]
    s_cmp_le_u32 s44, 52
    s_cbranch_scc1 L_f_rankd
    s_waitcnt lgkmcnt(2)
    v_cmp_gt_u32 s[46:47], v120, v27
    v_cmp_gt_u32 s[48:49], v121, v27
    v_cmp_gt_u32 s[50:51], v122, v27
    v_cmp_gt_u32 s[52:53], v123, v27
    v_addc_co_u32 v52, vcc, 0, v52, s[46:47]
    v_addc_co_u32 v52, vcc, 0, v52, s[48:49]
    v_addc_co_u32 v52, vcc, 0, v52, s[50:51]
    v_addc_co_u32 v52, vcc, 0, v52, s[52:53]
    s_cmp_le_u32 s44, 56
    s_cbranch_scc1 L_f_rankd
    s_waitcnt lgkmcnt(1)
    v_cmp_gt_u32 s[46:47], v124, v27
    v_cmp_gt_u32 s[48:49], v125, v27
    v_cmp_gt_u32 s[50:51], v126, v27
    v_cmp_gt_u32 s[52:53], v127, v27
    v_addc_co_u32 v52, vcc, 0, v52, s[46:47]
    v_addc_co_u32 v52, vcc, 0, v52, s[48:49]
    v_addc_co_u32 v52, vcc, 0, v52, s[50:51]
    v_addc_co_u32 v52, vcc, 0, v52, s[52:53]
    s_cmp_le_u32 s44, 60
    s_cbranch_scc1 L_f_rankd
    s_waitcnt lgkmcnt(0)
    v_cmp_gt_u32 s[46:47], v128, v27
    v_cmp_gt_u32 s[48:49], v129, v27
    v_cmp_gt_u32 s[50:51], v130, v27
    v_cmp_gt_u32 s[52:53], v131, v27
    v_addc_co_u32 v52, vcc, 0, v52, s[46:47]
    v_addc_co_u32 v52, vcc, 0, v52, s[48:49]
    v_addc_co_u32 v52, vcc, 0, v52, s[50:51]
    v_addc_co_u32 v52, vcc, 0, v52, s[52:53]
L_f_rankd:
    s_nop 0
    v_lshlrev_b32 v2, 2, v52
    v_cmp_gt_u32 vcc, 8, v52
    s_nop 3
    s_and_saveexec_b64 s[38:39], vcc
    ds_write_b32 v2, v27 offset:30976
    s_mov_b64 exec, -1
    s_branch L_t_norank
L_f_fallback:
    s_waitcnt lgkmcnt(0)
    s_and_b32 s6, s2, 7
    s_lshl_b32 s6, s6, 12
    s_add_u32 s6, s6, 65536
    v_lshl_add_u32 v2, v1, 6, s6
    global_load_dwordx4 v[100:103], v2, s[36:37] offset:0 sc1
    global_load_dwordx4 v[104:107], v2, s[36:37] offset:16 sc1
    global_load_dwordx4 v[108:111], v2, s[36:37] offset:32 sc1
    global_load_dwordx4 v[112:115], v2, s[36:37] offset:48 sc1
    v_lshlrev_b32 v4, 5, v1
    v_sub_u32 v4, 2047, v4
    s_waitcnt vmcnt(0)
    v_subrev_u32 v2, 0, v4
    v_subrev_u32 v3, 1, v4
    v_lshl_or_b32 v68, v100, 16, v2
    v_and_or_b32 v69, v100, s67, v3
    v_subrev_u32 v2, 2, v4
    v_subrev_u32 v3, 3, v4
    v_lshl_or_b32 v70, v101, 16, v2
    v_and_or_b32 v71, v101, s67, v3
    v_subrev_u32 v2, 4, v4
    v_subrev_u32 v3, 5, v4
    v_lshl_or_b32 v72, v102, 16, v2
    v_and_or_b32 v73, v102, s67, v3
    v_subrev_u32 v2, 6, v4
    v_subrev_u32 v3, 7, v4
    v_lshl_or_b32 v74, v103, 16, v2
    v_and_or_b32 v75, v103, s67, v3
    v_subrev_u32 v2, 8, v4
    v_subrev_u32 v3, 9, v4
    v_lshl_or_b32 v76, v104, 16, v2
    v_and_or_b32 v77, v104, s67, v3
    v_subrev_u32 v2, 10, v4
    v_subrev_u32 v3, 11, v4
    v_lshl_or_b32 v78, v105, 16, v2
    v_and_or_b32 v79, v105, s67, v3
    v_subrev_u32 v2, 12, v4
    v_subrev_u32 v3, 13, v4
    v_lshl_or_b32 v80, v106, 16, v2
    v_and_or_b32 v81, v106, s67, v3
    v_subrev_u32 v2, 14, v4
    v_subrev_u32 v3, 15, v4
    v_lshl_or_b32 v82, v107, 16, v2
    v_and_or_b32 v83, v107, s67, v3
    v_subrev_u32 v2, 16, v4
    v_subrev_u32 v3, 17, v4
    v_lshl_or_b32 v84, v108, 16, v2
    v_and_or_b32 v85, v108, s67, v3
    v_subrev_u32 v2, 18, v4
    v_subrev_u32 v3, 19, v4
    v_lshl_or_b32 v86, v109, 16, v2
    v_and_or_b32 v87, v109, s67, v3
    v_subrev_u32 v2, 20, v4
    v_subrev_u32 v3, 21, v4
    v_lshl_or_b32 v88, v110, 16, v2
    v_and_or_b32 v89, v110, s67, v3
    v_subrev_u32 v2, 22, v4
    v_subrev_u32 v3, 23, v4
    v_lshl_or_b32 v90, v111, 16, v2
    v_and_or_b32 v91, v111, s67, v3
    v_subrev_u32 v2, 24, v4
    v_subrev_u32 v3, 25, v4
    v_lshl_or_b32 v92, v112, 16, v2
    v_and_or_b32 v93, v112, s67, v3
    v_subrev_u32 v2, 26, v4
    v_subrev_u32 v3, 27, v4
    v_lshl_or_b32 v94, v113, 16, v2
    v_and_or_b32 v95, v113, s67, v3
    v_subrev_u32 v2, 28, v4
    v_subrev_u32 v3, 29, v4
    v_lshl_or_b32 v96, v114, 16, v2
    v_and_or_b32 v97, v114, s67, v3
    v_subrev_u32 v2, 30, v4
    v_subrev_u32 v3, 31, v4
    v_lshl_or_b32 v98, v115, 16, v2
    v_and_or_b32 v99, v115, s67, v3
    s_mov_b32 s44, 0
L_f_fb:
    v_max_u32 v24, v68, v69
    v_max3_u32 v24, v24, v70, v71
    v_max3_u32 v24, v24, v72, v73
    v_max3_u32 v24, v24, v74, v75
    v_max3_u32 v24, v24, v76, v77
    v_max3_u32 v24, v24, v78, v79
    v_max3_u32 v24, v24, v80, v81
    v_max3_u32 v24, v24, v82, v83
    v_max3_u32 v24, v24, v84, v85
    v_max3_u32 v24, v24, v86, v87
    v_max3_u32 v24, v24, v88, v89
    v_max3_u32 v24, v24, v90, v91
    v_max3_u32 v24, v24, v92, v93
    v_max3_u32 v24, v24, v94, v95
    v_max3_u32 v24, v24, v96, v97
    v_max3_u32 v24, v24, v98, v99
    s_nop 1
    v_max_u32_dpp v24, v24, v24 row_ror:1 row_mask:0xf bank_mask:0xf
    s_nop 1
    v_max_u32_dpp v24, v24, v24 row_ror:2 row_mask:0xf bank_mask:0xf
    s_nop 1
    v_max_u32_dpp v24, v24, v24 row_ror:4 row_mask:0xf bank_mask:0xf
    s_nop 1
    v_max_u32_dpp v24, v24, v24 row_ror:8 row_mask:0xf bank_mask:0xf
    v_mov_b32 v25, v24
    s_nop 1
    v_permlane16_swap_b32 v25, v24
    v_max_u32 v24, v24, v25
    v_mov_b32 v25, v24
    s_nop 1
    v_permlane32_swap_b32 v25, v24
    v_max_u32 v24, v24, v25
    v_cmp_ne_u32 vcc, v68, v24
    s_nop 1
    v_cndmask_b32 v68, 0, v68, vcc
    v_cmp_ne_u32 vcc, v69, v24
    s_nop 1
    v_cndmask_b32 v69, 0, v69, vcc
    v_cmp_ne_u32 vcc, v70, v24
    s_nop 1
    v_cndmask_b32 v70, 0, v70, vcc
    v_cmp_ne_u32 vcc, v71, v24
    s_nop 1
    v_cndmask_b32 v71, 0, v71, vcc
    v_cmp_ne_u32 vcc, v72, v24
    s_nop 1
    v_cndmask_b32 v72, 0, v72, vcc
    v_cmp_ne_u32 vcc, v73, v24
    s_nop 1
    v_cndmask_b32 v73, 0, v73, vcc
    v_cmp_ne_u32 vcc, v74, v24
    s_nop 1
    v_cndmask_b32 v74, 0, v74, vcc
    v_cmp_ne_u32 vcc, v75, v24
    s_nop 1
    v_cndmask_b32 v75, 0, v75, vcc
    v_cmp_ne_u32 vcc, v76, v24
    s_nop 1
    v_cndmask_b32 v76, 0, v76, vcc
    v_cmp_ne_u32 vcc, v77, v24
    s_nop 1
    v_cndmask_b32 v77, 0, v77, vcc
    v_cmp_ne_u32 vcc, v78, v24
    s_nop 1
    v_cndmask_b32 v78, 0, v78, vcc
    v_cmp_ne_u32 vcc, v79, v24
    s_nop 1
    v_cndmask_b32 v79, 0, v79, vcc
    v_cmp_ne_u32 vcc, v80, v24
    s_nop 1
    v_cndmask_b32 v80, 0, v80, vcc
    v_cmp_ne_u32 vcc, v81, v24
    s_nop 1
    v_cndmask_b32 v81, 0, v81, vcc
    v_cmp_ne_u32 vcc, v82, v24
    s_nop 1
    v_cndmask_b32 v82, 0, v82, vcc
    v_cmp_ne_u32 vcc, v83, v24
    s_nop 1
    v_cndmask_b32 v83, 0, v83, vcc
    v_cmp_ne_u32 vcc, v84, v24
    s_nop 1
    v_cndmask_b32 v84, 0, v84, vcc
    v_cmp_ne_u32 vcc, v85, v24
    s_nop 1
    v_cndmask_b32 v85, 0, v85, vcc
    v_cmp_ne_u32 vcc, v86, v24
    s_nop 1
    v_cndmask_b32 v86, 0, v86, vcc
    v_cmp_ne_u32 vcc, v87, v24
    s_nop 1
    v_cndmask_b32 v87, 0, v87, vcc
    v_cmp_ne_u32 vcc, v88, v24
    s_nop 1
    v_cndmask_b32 v88, 0, v88, vcc
    v_cmp_ne_u32 vcc, v89, v24
    s_nop 1
    v_cndmask_b32 v89, 0, v89, vcc
    v_cmp_ne_u32 vcc, v90, v24
    s_nop 1
    v_cndmask_b32 v90, 0, v90, vcc
    v_cmp_ne_u32 vcc, v91, v24
    s_nop 1
    v_cndmask_b32 v91, 0, v91, vcc
    v_cmp_ne_u32 vcc, v92, v24
    s_nop 1
    v_cndmask_b32 v92, 0, v92, vcc
    v_cmp_ne_u32 vcc, v93, v24
    s_nop 1
    v_cndmask_b32 v93, 0, v93, vcc
    v_cmp_ne_u32 vcc, v94, v24
    s_nop 1
    v_cndmask_b32 v94, 0, v94, vcc
    v_cmp_ne_u32 vcc, v95, v24
    s_nop 1
    v_cndmask_b32 v95, 0, v95, vcc
    v_cmp_ne_u32 vcc, v96, v24
    s_nop 1
    v_cndmask_b32 v96, 0, v96, vcc
    v_cmp_ne_u32 vcc, v97, v24
    s_nop 1
    v_cndmask_b32 v97, 0, v97, vcc
    v_cmp_ne_u32 vcc, v98, v24
    s_nop 1
    v_cndmask_b32 v98, 0, v98, vcc
    v_cmp_ne_u32 vcc, v99, v24
    s_nop 1
    v_cndmask_b32 v99, 0, v99, vcc
    s_lshl_b32 s6, s44, 2
    s_add_u32 s6, s6, 30976
    v_mov_b32 v2, s6
    s_mov_b64 exec, 1
    ds_write_b32 v2, v24
    s_mov_b64 exec, -1
    s_add_u32 s44, s44, 1
    s_cmp_lt_u32 s44, 8
    s_cbranch_scc1 L_f_fb
L_t_norank:
    s_waitcnt lgkmcnt(0)
    s_barrier
    s_branch L_t_join
L_t_roleB:
    global_store_dwordx4 v12, v[64:67], s[32:33] sc1
    s_cmp_lt_u32 s2, 56
    s_cbranch_scc0 L_w_not1
    s_sub_u32 s6, s4, 4
    v_lshrrev_b32 v2, 2, v1
    v_mul_u32_u24 v2, 3584, v2
    v_and_b32 v3, 3, v1
    v_lshl_add_u32 v2, v3, 4, v2
    s_lshl_b32 s7, s61, 6
    s_and_b32 s38, s6, 1
    s_mul_i32 s39, s38, 917504
    s_add_u32 s7, s7, s39
    v_add_u32 v2, s7, v2
    s_lshl_b32 s39, s6, 14
    s_add_u32 s39, s39, 47360
    s_cmp_ge_u32 s6, 2
    s_cselect_b32 s44, s28, s26
    s_cselect_b32 s45, s29, s27
    s_mov_b32 s38, 16
    s_mov_b32 s7, 57344
    s_branch L_w_loop
L_w_not1:
    s_sub_u32 s6, s4, 4
    v_lshrrev_b32 v2, 1, v1
    v_lshlrev_b32 v2, 10, v2
    v_and_b32 v3, 1, v1
    v_lshl_add_u32 v2, v3, 4, v2
    s_lshl_b32 s7, s61, 5
    s_mul_i32 s39, s6, 458752
    s_add_u32 s7, s7, s39
    v_add_u32 v2, s7, v2
    s_mul_i32 s39, s6, 14336
    s_add_u32 s39, s39, 47360
    s_mov_b32 s44, s30
    s_mov_b32 s45, s31
    s_mov_b32 s38, 14
    s_mov_b32 s7, 32768
L_w_loop:
    s_mov_b32 m0, s39
    s_add_u32 s39, s39, 1024
    global_load_lds_dwordx4 v2, s[44:45]
    v_add_u32 v2, s7, v2
    s_sub_u32 s38, s38, 1
    s_cmp_lg_u32 s38, 0
    s_cbranch_scc1 L_w_loop
    s_barrier
    s_barrier
    s_barrier
L_t_join:
    v_lshlrev_b32 v2, 2, v8
    ds_read_b32 v14, v2 offset:30976
    v_lshrrev_b32 v2, 4, v1
    v_lshlrev_b32 v2, 3, v2
    v_bfe_u32 v3, v1, 2, 2
    v_add_u32 v2, v2, v3
    v_and_b32 v3, 3, v1
    s_waitcnt lgkmcnt(0)
    v_and_b32 v15, 0xffff, v14
    v_sub_u32 v15, 2047, v15
    v_mov_b32 v49, v2
    v_mov_b32 v50, v3
    v_lshlrev_b32 v56, 2, v15
    v_add_u32 v56, 262144, v56
    s_cmp_eq_u32 s43, 1
    s_cbranch_scc0 L_f2
    v_lshrrev_b32 v2, 4, v1
    v_lshlrev_b32 v2, 4, v2
    v_lshl_add_u32 v2, v15, 10, v2
    s_lshl_b32 s6, s4, 7
    s_add_u32 s6, s6, 5242880
    v_add_u32 v57, s6, v2
    global_load_dword v51, v56, s[36:37] sc1
    global_load_dwordx4 v[68:71], v57, s[36:37] sc1
    global_load_dwordx4 v[72:75], v57, s[36:37] offset:64 sc1
    s_waitcnt vmcnt(3)
    s_barrier
    v_lshlrev_b32 v48, 6, v49
    v_lshl_add_u32 v48, v50, 3, v48
    s_lshl_b32 s6, s4, 12
    s_add_u32 s6, s6, 47360
    v_add_u32 v48, s6, v48
    ds_read_b64_tr_b16 v[16:17], v48 offset:0
    ds_read_b64_tr_b16 v[18:19], v48 offset:256
    ds_read_b64_tr_b16 v[20:21], v48 offset:32
    ds_read_b64_tr_b16 v[22:23], v48 offset:288
    ds_read_b64_tr_b16 v[24:25], v48 offset:32768
    ds_read_b64_tr_b16 v[26:27], v48 offset:33024
    ds_read_b64_tr_b16 v[28:29], v48 offset:32800
    ds_read_b64_tr_b16 v[30:31], v48 offset:33056
    ds_read_b64_tr_b16 v[32:33], v48 offset:2048
    ds_read_b64_tr_b16 v[34:35], v48 offset:2304
    ds_read_b64_tr_b16 v[36:37], v48 offset:2080
    ds_read_b64_tr_b16 v[38:39], v48 offset:2336
    ds_read_b64_tr_b16 v[40:41], v48 offset:34816
    ds_read_b64_tr_b16 v[42:43], v48 offset:35072
    ds_read_b64_tr_b16 v[44:45], v48 offset:34848
    ds_read_b64_tr_b16 v[46:47], v48 offset:35104
    s_mov_b32 s60, 0
    s_branch L_hf_15
L_h_13:
    global_load_dword v51, v56, s[36:37] sc1
    global_load_dwordx4 v[68:71], v57, s[36:37] sc1
    global_load_dwordx4 v[72:75], v57, s[36:37] offset:64 sc1
L_hf_15:
    s_waitcnt vmcnt(0)
    v_max_u32 v3, v51, v68
    v_max3_u32 v3, v3, v69, v70
    v_max3_u32 v3, v3, v71, v72
    v_max3_u32 v3, v3, v73, v74
    v_max_u32 v3, v3, v75
    v_cmp_eq_u32 vcc, -1, v3
    s_nop 3
    s_cbranch_vccz L_hok_14
    s_mov_b64 exec, vcc
    s_add_u32 s60, s60, 1
    s_cmp_lt_u32 s60, 32768
    s_cbranch_scc1 L_h_13
L_hok_14:
    s_mov_b64 exec, -1
    v_lshlrev_b32 v52, 16, v51
    v_and_b32 v3, s67, v51
    v_rcp_f32 v54, v3
    v_lshlrev_b32 v84, 16, v68
    v_and_b32 v85, s67, v68
    v_lshlrev_b32 v86, 16, v69
    v_and_b32 v87, s67, v69
    v_lshlrev_b32 v88, 16, v70
    v_and_b32 v89, s67, v70
    v_lshlrev_b32 v90, 16, v71
    v_and_b32 v91, s67, v71
    v_lshlrev_b32 v124, 16, v72
    v_and_b32 v125, s67, v72
    v_lshlrev_b32 v126, 16, v73
    v_and_b32 v127, s67, v73
    v_lshlrev_b32 v128, 16, v74
    v_and_b32 v129, s67, v74
    v_lshlrev_b32 v130, 16, v75
    v_and_b32 v131, s67, v75
    v_pk_add_f32 v[76:77], v[84:85], v[52:53] op_sel_hi:[1,0] neg_lo:[0,1] neg_hi:[0,1]
    v_pk_add_f32 v[78:79], v[86:87], v[52:53] op_sel_hi:[1,0] neg_lo:[0,1] neg_hi:[0,1]
    v_pk_add_f32 v[80:81], v[88:89], v[52:53] op_sel_hi:[1,0] neg_lo:[0,1] neg_hi:[0,1]
    v_pk_add_f32 v[82:83], v[90:91], v[52:53] op_sel_hi:[1,0] neg_lo:[0,1] neg_hi:[0,1]
    v_pk_add_f32 v[116:117], v[124:125], v[52:53] op_sel_hi:[1,0] neg_lo:[0,1] neg_hi:[0,1]
    v_pk_add_f32 v[118:119], v[126:127], v[52:53] op_sel_hi:[1,0] neg_lo:[0,1] neg_hi:[0,1]
    v_pk_add_f32 v[120:121], v[128:129], v[52:53] op_sel_hi:[1,0] neg_lo:[0,1] neg_hi:[0,1]
    v_pk_add_f32 v[122:123], v[130:131], v[52:53] op_sel_hi:[1,0] neg_lo:[0,1] neg_hi:[0,1]
    v_cvt_pk_bf16_f32 v92, v76, v77
    v_cvt_pk_bf16_f32 v93, v78, v79
    v_cvt_pk_bf16_f32 v94, v80, v81
    v_cvt_pk_bf16_f32 v95, v82, v83
    v_cvt_pk_bf16_f32 v96, v116, v117
    v_cvt_pk_bf16_f32 v97, v118, v119
    v_cvt_pk_bf16_f32 v98, v120, v121
    v_cvt_pk_bf16_f32 v99, v122, v123
    v_lshlrev_b32 v76, 16, v92
    v_and_b32 v77, s67, v92
    v_lshlrev_b32 v78, 16, v93
    v_and_b32 v79, s67, v93
    v_lshlrev_b32 v80, 16, v94
    v_and_b32 v81, s67, v94
    v_lshlrev_b32 v82, 16, v95
    v_and_b32 v83, s67, v95
    v_lshlrev_b32 v116, 16, v96
    v_and_b32 v117, s67, v96
    v_lshlrev_b32 v118, 16, v97
    v_and_b32 v119, s67, v97
    v_lshlrev_b32 v120, 16, v98
    v_and_b32 v121, s67, v98
    v_lshlrev_b32 v122, 16, v99
    v_and_b32 v123, s67, v99
    v_pk_mul_f32 v[76:77], v[76:77], v[54:55] op_sel_hi:[1,0]
    v_pk_mul_f32 v[78:79], v[78:79], v[54:55] op_sel_hi:[1,0]
    v_pk_mul_f32 v[80:81], v[80:81], v[54:55] op_sel_hi:[1,0]
    v_pk_mul_f32 v[82:83], v[82:83], v[54:55] op_sel_hi:[1,0]
    v_pk_mul_f32 v[116:117], v[116:117], v[54:55] op_sel_hi:[1,0]
    v_pk_mul_f32 v[118:119], v[118:119], v[54:55] op_sel_hi:[1,0]
    v_pk_mul_f32 v[120:121], v[120:121], v[54:55] op_sel_hi:[1,0]
    v_pk_mul_f32 v[122:123], v[122:123], v[54:55] op_sel_hi:[1,0]
    v_cvt_pk_bf16_f32 v92, v76, v77
    v_cvt_pk_bf16_f32 v93, v78, v79
    v_cvt_pk_bf16_f32 v94, v80, v81
    v_cvt_pk_bf16_f32 v95, v82, v83
    v_cvt_pk_bf16_f32 v96, v116, v117
    v_cvt_pk_bf16_f32 v97, v118, v119
    v_cvt_pk_bf16_f32 v98, v120, v121
    v_cvt_pk_bf16_f32 v99, v122, v123
    s_lshl_b32 s6, s4, 11
    s_add_u32 s6, s6, 116992
    v_lshl_add_u32 v2, v1, 4, s6
    s_waitcnt lgkmcnt(0)
    v_mfma_f32_16x16x32_bf16 v[100:103], v[92:95], v[16:19], 0
    v_mfma_f32_16x16x32_bf16 v[104:107], v[92:95], v[20:23], 0
    v_mfma_f32_16x16x32_bf16 v[108:111], v[92:95], v[24:27], 0
    v_mfma_f32_16x16x32_bf16 v[112:115], v[92:95], v[28:31], 0
    v_mfma_f32_16x16x32_bf16 v[100:103], v[96:99], v[32:35], v[100:103]
    v_mfma_f32_16x16x32_bf16 v[104:107], v[96:99], v[36:39], v[104:107]
    v_mfma_f32_16x16x32_bf16 v[108:111], v[96:99], v[40:43], v[108:111]
    v_mfma_f32_16x16x32_bf16 v[112:115], v[96:99], v[44:47], v[112:115]
    s_mov_b32 exec_hi, 0
    s_nop 3
    ds_write_b128 v2, v[100:103] offset:0
    ds_write_b128 v2, v[104:107] offset:512
    ds_write_b128 v2, v[108:111] offset:1024
    ds_write_b128 v2, v[112:115] offset:1536
    s_mov_b32 exec_hi, -1
    s_lshr_b32 s6, s4, 1
    s_lshl_b32 s6, s6, 9
    s_and_b32 s7, s4, 1
    s_lshl_b32 s7, s7, 8
    s_add_u32 s6, s6, s7
    s_add_u32 s6, s6, 116992
    v_lshl_add_u32 v4, v1, 2, s6
    s_waitcnt lgkmcnt(0)
    s_barrier
    s_cmp_eq_u32 s4, 5
    s_cbranch_scc0 L_f1_nof3b
    s_lshl_b32 s6, s3, 4
    s_add_u32 s6, s6, 360448
    v_lshl_add_u32 v2, v1, 12, s6
    v_mov_b32 v3, s5
    s_mov_b64 exec, 0xff
    global_store_dword v2, v3, s[36:37] sc1
    s_mov_b64 exec, -1
L_f1_nof3b:
    s_cmp_ge_u32 s4, 4
    s_cbranch_scc1 L_fin
    ds_read2st64_b32 v[116:117], v4 offset0:0 offset1:8
    ds_read2st64_b32 v[118:119], v4 offset0:16 offset1:24
    ds_read2st64_b32 v[120:121], v4 offset0:32 offset1:40
    ds_read2st64_b32 v[122:123], v4 offset0:48 offset1:56
    ds_read2st64_b32 v[124:125], v4 offset0:4 offset1:12
    ds_read2st64_b32 v[126:127], v4 offset0:20 offset1:28
    ds_read2st64_b32 v[128:129], v4 offset0:36 offset1:44
    ds_read2st64_b32 v[130:131], v4 offset0:52 offset1:60
    v_and_b32 v57, 3, v1
    v_lshlrev_b32 v57, 5, v57
    v_lshrrev_b32 v2, 2, v1
    v_lshl_add_u32 v57, v2, 1, v57
    s_lshl_b32 s6, s4, 7
    s_lshl_b32 s7, s61, 9
    s_add_u32 s6, s6, s7
    s_add_u32 s6, s6, 131072
    v_add_u32 v57, s6, v57
    s_waitcnt lgkmcnt(4)
    v_add_f32 v116, v116, v117
    v_add_f32 v118, v118, v119
    v_add_f32 v120, v120, v121
    v_add_f32 v122, v122, v123
    v_add_f32 v116, v116, v118
    v_add_f32 v120, v120, v122
    v_add_f32 v116, v116, v120
    s_waitcnt lgkmcnt(0)
    v_add_f32 v124, v124, v125
    v_add_f32 v126, v126, v127
    v_add_f32 v128, v128, v129
    v_add_f32 v130, v130, v131
    v_add_f32 v124, v124, v126
    v_add_f32 v128, v128, v130
    v_add_f32 v124, v124, v128
    v_cvt_pk_bf16_f32 v117, v116, v124
    v_lshlrev_b32 v116, 16, v117
    v_and_b32 v124, s67, v117
    v_mul_f32 v118, 0xbfb8aa3b, v116
    v_exp_f32 v118, v118
    s_nop 0
    v_add_f32 v118, 1.0, v118
    v_rcp_f32 v118, v118
    s_nop 0
    v_mul_f32 v116, v116, v118
    v_cvt_pk_bf16_f32 v116, v116, v116
    v_lshlrev_b32 v116, 16, v116
    v_mul_f32 v116, v116, v124
    s_nop 1
    v_mov_b32_dpp v117, v116 row_shl:4 row_mask:0xf bank_mask:0xf
    v_cvt_pk_bf16_f32 v116, v116, v117
    s_mov_b32 exec_lo, 0x0f0f0f0f
    s_mov_b32 exec_hi, 0x0f0f0f0f
    global_store_dword v57, v116, s[36:37] sc1
    v_add_u32 v57, 28672, v57
    global_store_dword v57, v116, s[36:37] sc1
    v_add_u32 v57, 28672, v57
    global_store_dword v57, v116, s[36:37] sc1
    v_add_u32 v57, 28672, v57
    global_store_dword v57, v116, s[36:37] sc1
    s_mov_b64 exec, -1
    s_branch L_fin
L_f2:
    v_lshrrev_b32 v2, 4, v0
    v_and_b32 v2, 7, v2
    v_lshlrev_b32 v2, 2, v2
    ds_read_b32 v96, v2 offset:30976
    s_waitcnt lgkmcnt(0)
    v_and_b32 v97, 0xffff, v96
    v_sub_u32 v97, 2047, v97
    s_lshl_b32 s7, s61, 5
    v_and_b32 v2, 15, v1
    v_lshlrev_b32 v2, 1, v2
    v_lshl_add_u32 v57, v97, 10, v2
    v_add_u32 v57, s7, v57
    v_and_b32 v98, 0xfffffffc, v57
    v_add_u32 v98, 5242880, v98
    v_lshlrev_b32 v99, 2, v97
    v_add_u32 v99, 262144, v99
    s_mov_b32 s60, 0
L_h2_16:
    global_load_dword v58, v98, s[36:37] sc1
    global_load_dword v59, v99, s[36:37] sc1
    s_waitcnt vmcnt(0)
    v_max_u32 v2, v58, v59
    v_cmp_eq_u32 vcc, -1, v2
    s_nop 3
    s_cbranch_vccz L_h2ok_17
    s_mov_b64 exec, vcc
    s_add_u32 s60, s60, 1
    s_cmp_lt_u32 s60, 32768
    s_cbranch_scc1 L_h2_16
L_h2ok_17:
    s_mov_b64 exec, -1
    v_and_b32 v2, 1, v1
    v_cmp_eq_u32 vcc, 1, v2
    v_lshrrev_b32 v2, 16, v58
    v_and_b32 v58, 0xffff, v58
    v_cndmask_b32 v58, v58, v2, vcc
    s_waitcnt vmcnt(0)
    s_barrier
    s_cmp_eq_u32 s4, 2
    s_cbranch_scc0 L_f3b_18
    s_lshl_b32 s6, s3, 4
    s_add_u32 s6, s6, 360448
    v_lshl_add_u32 v2, v1, 12, s6
    v_mov_b32 v3, s5
    s_mov_b64 exec, 0xff
    global_store_dword v2, v3, s[36:37] sc1
    s_mov_b64 exec, -1
L_f3b_18:
    v_lshlrev_b32 v48, 5, v49
    v_lshl_add_u32 v48, v50, 3, v48
    s_mul_i32 s6, s4, 7168
    s_add_u32 s6, s6, 47360
    v_add_u32 v48, s6, v48
    ds_read_b64_tr_b16 v[16:17], v48 offset:0
    ds_read_b64_tr_b16 v[18:19], v48 offset:128
    ds_read_b64_tr_b16 v[20:21], v48 offset:1024
    ds_read_b64_tr_b16 v[22:23], v48 offset:1152
    ds_read_b64_tr_b16 v[24:25], v48 offset:2048
    ds_read_b64_tr_b16 v[26:27], v48 offset:2176
    ds_read_b64_tr_b16 v[28:29], v48 offset:3072
    ds_read_b64_tr_b16 v[30:31], v48 offset:3200
    ds_read_b64_tr_b16 v[32:33], v48 offset:4096
    ds_read_b64_tr_b16 v[34:35], v48 offset:4224
    ds_read_b64_tr_b16 v[36:37], v48 offset:5120
    ds_read_b64_tr_b16 v[38:39], v48 offset:5248
    ds_read_b64_tr_b16 v[40:41], v48 offset:6144
    ds_read_b64_tr_b16 v[42:43], v48 offset:6272
    s_and_b32 s6, s2, 7
    s_lshl_b32 s6, s6, 12
    s_add_u32 s6, s6, 360448
    v_lshrrev_b32 v99, 3, v15
    v_lshl_add_u32 v99, v99, 4, s6
    v_lshrrev_b32 v2, 16, v96
    v_cmp_lt_u32 vcc, 0x7fff, v2
    v_and_b32 v4, 0x7fff, v2
    v_xor_b32 v5, 0xffff, v2
    v_cndmask_b32 v2, v5, v4, vcc
    v_lshlrev_b32 v2, 16, v2
    v_mul_f32 v2, 0xbfb8aa3b, v2
    v_exp_f32 v2, v2
    s_nop 0
    v_add_f32 v2, 1.0, v2
    v_rcp_f32 v2, v2
    s_nop 0
    v_cvt_pk_bf16_f32 v2, v2, v2
    v_lshlrev_b32 v100, 16, v2
    v_lshlrev_b32 v58, 16, v58
    v_lshlrev_b32 v4, 16, v59
    v_and_b32 v5, s67, v59
    v_rcp_f32 v5, v5
    v_sub_f32 v4, v58, v4
    v_cvt_pk_bf16_f32 v4, v4, v4
    v_lshlrev_b32 v4, 16, v4
    v_mul_f32 v4, v4, v5
    v_cvt_pk_bf16_f32 v4, v4, v4
    v_lshlrev_b32 v101, 16, v4
    s_and_b32 s6, s2, 3
    s_mul_i32 s6, s6, 28672
    s_mul_i32 s7, s4, 3584
    s_add_u32 s6, s6, s7
    s_add_u32 s6, s6, 131072
    v_lshrrev_b32 v2, 5, v1
    v_lshlrev_b32 v2, 8, v2
    v_lshrrev_b32 v3, 2, v8
    v_lshl_add_u32 v2, v3, 7, v2
    v_and_b32 v3, 3, v8
    v_lshl_add_u32 v2, v3, 5, v2
    v_bfe_u32 v3, v1, 4, 1
    v_lshl_add_u32 v2, v3, 4, v2
    v_add_u32 v102, s6, v2
    s_lshl_b32 s6, s4, 9
    s_add_u32 s6, s6, 116992
    v_lshl_add_u32 v103, v1, 4, s6
    v_lshrrev_b32 v2, 4, v0
    v_lshrrev_b32 v3, 2, v2
    v_lshlrev_b32 v3, 8, v3
    v_and_b32 v2, 3, v2
    v_lshl_add_u32 v3, v2, 2, v3
    v_and_b32 v2, 15, v1
    v_lshl_add_u32 v3, v2, 4, v3
    v_add_u32 v104, 116992, v3
    s_cmp_ge_u32 s4, 2
    s_cbranch_scc1 L_f2_nof3b
    s_mov_b32 s60, 0
L_f3b_19:
    global_load_dword v98, v99, s[36:37] sc1
    s_waitcnt vmcnt(0)
    v_xor_b32 v2, s5, v98
    v_cmp_ne_u32 vcc, 0, v2
    s_nop 3
    s_cbranch_vccz L_f3bok_20
    s_mov_b64 exec, vcc
    s_add_u32 s60, s60, 1
    s_cmp_lt_u32 s60, 32768
    s_cbranch_scc1 L_f3b_19
L_f3bok_20:
    s_mov_b64 exec, -1
L_f2_nof3b:
    s_mov_b32 s60, 0
L_hid_21:
    global_load_dwordx4 v[68:71], v102, s[36:37] offset:0 sc1
    global_load_dwordx4 v[72:75], v102, s[36:37] offset:512 sc1
    global_load_dwordx4 v[76:79], v102, s[36:37] offset:1024 sc1
    global_load_dwordx4 v[80:83], v102, s[36:37] offset:1536 sc1
    global_load_dwordx4 v[84:87], v102, s[36:37] offset:2048 sc1
    global_load_dwordx4 v[88:91], v102, s[36:37] offset:2560 sc1
    global_load_dwordx4 v[92:95], v102, s[36:37] offset:3072 sc1
    s_waitcnt vmcnt(0)
    v_max_u32 v2, v68, v69
    v_max3_u32 v2, v2, v70, v71
    v_max3_u32 v2, v2, v72, v73
    v_max3_u32 v2, v2, v74, v75
    v_max3_u32 v2, v2, v76, v77
    v_max3_u32 v2, v2, v78, v79
    v_max3_u32 v2, v2, v80, v81
    v_max3_u32 v2, v2, v82, v83
    v_max3_u32 v2, v2, v84, v85
    v_max3_u32 v2, v2, v86, v87
    v_max3_u32 v2, v2, v88, v89
    v_max3_u32 v2, v2, v90, v91
    v_max3_u32 v2, v2, v92, v93
    v_max3_u32 v2, v2, v94, v95
    v_cmp_eq_u32 vcc, -1, v2
    s_nop 3
    s_cbranch_vccz L_hidok_22
    s_mov_b64 exec, vcc
    s_add_u32 s60, s60, 1
    s_cmp_lt_u32 s60, 32768
    s_cbranch_scc1 L_hid_21
L_hidok_22:
    s_mov_b64 exec, -1
    v_mfma_f32_16x16x32_bf16 v[60:63], v[68:71], v[16:19], 0
    v_mfma_f32_16x16x32_bf16 v[108:111], v[72:75], v[20:23], 0
    v_mfma_f32_16x16x32_bf16 v[60:63], v[76:79], v[24:27], v[60:63]
    v_mfma_f32_16x16x32_bf16 v[108:111], v[80:83], v[28:31], v[108:111]
    v_mfma_f32_16x16x32_bf16 v[60:63], v[84:87], v[32:35], v[60:63]
    v_mfma_f32_16x16x32_bf16 v[108:111], v[88:91], v[36:39], v[108:111]
    v_mfma_f32_16x16x32_bf16 v[60:63], v[92:95], v[40:43], v[60:63]
    s_nop 7
    v_pk_add_f32 v[60:61], v[60:61], v[108:109]
    v_pk_add_f32 v[62:63], v[62:63], v[110:111]
    s_mov_b32 exec_hi, 0
    ds_write_b128 v103, v[60:63]
    s_mov_b32 exec_hi, -1
    s_waitcnt lgkmcnt(0)
    s_barrier
    s_cmp_ge_u32 s4, 2
    s_cbranch_scc1 L_fin
    ds_read2st64_b32 v[112:113], v104 offset0:0 offset1:2
    ds_read2st64_b32 v[114:115], v104 offset0:4 offset1:6
    ds_read2st64_b32 v[116:117], v104 offset0:8 offset1:10
    ds_read2st64_b32 v[118:119], v104 offset0:12 offset1:14
    s_waitcnt lgkmcnt(0)
    v_add_f32 v112, v112, v113
    v_add_f32 v114, v114, v115
    v_add_f32 v116, v116, v117
    v_add_f32 v118, v118, v119
    v_add_f32 v112, v112, v114
    v_add_f32 v116, v116, v118
    v_add_f32 v112, v112, v116
    v_cvt_pk_bf16_f32 v112, v112, v112
    v_lshlrev_b32 v112, 16, v112
    v_mul_f32 v112, v112, v100
    v_cvt_pk_bf16_f32 v112, v112, v112
    v_lshlrev_b32 v112, 16, v112
    v_add_f32 v112, v112, v101
    v_cvt_pk_bf16_f32 v112, v112, v112
    v_lshlrev_b32 v112, 16, v112
    v_add_f32 v112, v112, v58
    v_cvt_pk_bf16_f32 v112, v112, v112
    global_store_short v57, v112, s[32:33] sc1
L_fin:
    s_cmp_eq_u32 s2, 0
    s_cbranch_scc0 L_end
    s_cmp_eq_u32 s4, 0
    s_cbranch_scc0 L_end
    v_mov_b32 v2, 0
    v_mov_b32 v3, s5
    s_mov_b64 exec, 1
    global_store_dword v2, v3, s[36:37]
L_end:
    s_endpgm
.section .rodata,"a"
.p2align 6
.amdhsa_kernel sequential_preLN__ssm_conv_s4d__moe_arch_mod__prompt_kernel
  .amdhsa_next_free_vgpr 256
  .amdhsa_next_free_sgpr 102
  .amdhsa_accum_offset 256
  .amdhsa_group_segment_fixed_size 0
  .amdhsa_kernarg_size 120
  .amdhsa_user_sgpr_count 2
  .amdhsa_user_sgpr_kernarg_segment_ptr 1
  .amdhsa_system_sgpr_workgroup_id_x 1
.end_amdhsa_kernel
```
